```python
import torch

def _softmax(x, axis=-1):
    return torch.softmax(x, dim=axis)
def _gelu(x):
    return torch.nn.functional.gelu(x, approximate="tanh")
def _silu(x):
    return torch.nn.functional.silu(x)
def _sigmoid(x):
    return torch.sigmoid(x)
def _layernorm(x, axis=-1, eps=1e-5):
    m = x.mean(dim=axis, keepdim=True)
    v = x.var(dim=axis, keepdim=True, unbiased=False)
    return (x - m) / torch.sqrt(v + eps)
def _scatter_add(tgt, idx, src, axis=0):
    return tgt.clone().index_add_(axis, idx, src)
def _segment_sum(src, seg, n):
    out = torch.zeros((n,) + src.shape[1:], dtype=src.dtype)
    return out.index_add_(0, seg, src)
def _pad(x, pw):
    flat = tuple(v for pair in reversed(pw) for v in pair)
    return torch.nn.functional.pad(x, flat)

kernel_name = 'standalone__gqa_softmax__sampling'

def setup_inputs():

    _w = (lambda a: (lambda t: t.to(torch.bfloat16) if t.is_floating_point() else t)(torch.as_tensor(a)))
    B, Hq, Hkv, Sq, Sk, D = 8, 32, 8, 1, 4096, 128
    return {
        "q": _w((lambda *s: torch.randn(*s, dtype=torch.bfloat16) * 0.8)(B, Hq, Sq, D)),
        "k": _w((lambda *s: torch.randn(*s, dtype=torch.bfloat16) * 0.8)(B, Hkv, Sk, D)),
        "v": _w((lambda *s: torch.randn(*s, dtype=torch.bfloat16) * 0.05)(B, Hkv, Sk, D)),
    }

def reference(q, k, v):
    B, Hq, Sq, D = q.shape
    Hkv = k.shape[1]
    rep = Hq // Hkv
    k = (lambda x, n, axis: torch.repeat_interleave(x, n, dim=axis))(k, rep, axis=1)
    v = (lambda x, n, axis: torch.repeat_interleave(x, n, dim=axis))(v, rep, axis=1)
    scale = D ** -0.5
    scores = torch.einsum("bhqd,bhkd->bhqk", q, k) * scale
    p = _softmax(scores, axis=-1)
    return torch.einsum("bhqk,bhkd->bhqd", p, v)
```

```asm
; @launch grid=(256,1,1) block=(256,1,1) lds=8384
.amdgcn_target "amdgcn-amd-amdhsa--gfx950"
.text
.globl standalone__gqa_softmax__sampling_kernel
.p2align 8
.type standalone__gqa_softmax__sampling_kernel,@function
standalone__gqa_softmax__sampling_kernel:
    s_load_dwordx2 s[16:17], s[0:1], 8
    s_cmp_ge_u32 s2, 256
    s_cbranch_scc1 L_end
    v_lshrrev_b32 v5, 6, v0
    s_and_b32 s36, s2, 7
    v_readfirstlane_b32 s3, v5
    s_lshr_b32 s2, s2, 3
    v_and_b32 v6, 48, v0
    s_lshl_b32 s36, s36, 5
    v_and_b32 v5, 15, v0
    s_or_b32 s2, s2, s36
    v_lshl_add_u32 v2, v5, 6, v6
    s_lshl_b32 s44, s3, 12
    s_lshl_b32 s45, s2, 18
    s_add_u32 s44, s44, s45
    s_mov_b32 s18, 0x4000000
    s_mov_b32 s19, 0x20000
    s_mov_b32 s45, s44
    s_waitcnt lgkmcnt(0)
    buffer_load_dwordx4 v[112:115], v2, s[16:19], s44 offen offset:0 nt
    buffer_load_dwordx4 v[116:119], v2, s[16:19], s44 offen offset:1024 nt
    buffer_load_dwordx4 v[120:123], v2, s[16:19], s44 offen offset:2048 nt
    buffer_load_dwordx4 v[124:127], v2, s[16:19], s44 offen offset:3072 nt
    s_add_u32 s44, s44, 16384
    s_load_dwordx2 s[24:25], s[0:1], 0
    s_load_dwordx2 s[20:21], s[0:1], 16
    s_load_dwordx2 s[28:29], s[0:1], 24
    s_load_dwordx2 s[12:13], s[0:1], 32
    s_load_dwordx2 s[32:33], s[0:1], 40
    v_and_b32 v1, 63, v0
    v_and_b32 v5, 3, v0
    v_lshl_add_u32 v4, v5, 8, v6
    v_lshlrev_b32 v10, 4, v5
    v_bfe_u32 v5, v0, 2, 2
    v_lshl_add_u32 v4, v5, 6, v4
    s_lshr_b32 s38, s2, 2
    s_lshl_b32 s39, s38, 10
    s_mov_b32 s26, 0x10000
    s_mov_b32 s27, 0x20000
    s_mov_b32 s22, 0x4000000
    s_mov_b32 s23, 0x20000
    s_mov_b32 s30, 0x10000
    s_mov_b32 s31, 0x20000
    s_mov_b32 s34, 0x200000
    s_mov_b32 s35, 0x20000
    v_lshlrev_b32 v3, 4, v1
    s_and_b32 s37, s2, 3
    s_lshl_b32 s47, s3, 11
    s_lshl_b32 s48, s38, 13
    s_add_u32 s53, s47, s48
    v_lshlrev_b32 v15, 3, v1
    v_mov_b32 v13, 0
    s_waitcnt lgkmcnt(0)
    buffer_load_dwordx4 v[16:19], v4, s[24:27], s39 offen
    buffer_load_dwordx4 v[128:131], v2, s[16:19], s44 offen offset:0 nt
    buffer_load_dwordx4 v[132:135], v2, s[16:19], s44 offen offset:1024 nt
    buffer_load_dwordx4 v[136:139], v2, s[16:19], s44 offen offset:2048 nt
    buffer_load_dwordx4 v[140:143], v2, s[16:19], s44 offen offset:3072 nt
    s_add_u32 s44, s44, 16384
    s_cmp_lg_u32 s37, 3
    s_cbranch_scc1 L_noclear
    v_mov_b32 v24, -1
    v_mov_b32 v25, -1
    v_mov_b32 v26, -1
    v_mov_b32 v27, -1
    buffer_store_dwordx4 v[24:27], v3, s[32:35], s53 offen
    s_mov_b32 exec_hi, 0xff
    buffer_store_dwordx4 v[24:27], v3, s[32:35], s53 offen offset:1024
    s_mov_b64 exec, -1
L_noclear:
    buffer_load_dwordx4 v[144:147], v2, s[16:19], s44 offen offset:0 nt
    buffer_load_dwordx4 v[148:151], v2, s[16:19], s44 offen offset:1024 nt
    buffer_load_dwordx4 v[152:155], v2, s[16:19], s44 offen offset:2048 nt
    buffer_load_dwordx4 v[156:159], v2, s[16:19], s44 offen offset:3072 nt
    s_add_u32 s44, s44, 16384
    buffer_load_dwordx4 v[160:163], v2, s[16:19], s44 offen offset:0 nt
    buffer_load_dwordx4 v[164:167], v2, s[16:19], s44 offen offset:1024 nt
    buffer_load_dwordx4 v[168:171], v2, s[16:19], s44 offen offset:2048 nt
    buffer_load_dwordx4 v[172:175], v2, s[16:19], s44 offen offset:3072 nt
    s_add_u32 s44, s44, 16384
    buffer_load_dwordx4 v[176:179], v2, s[16:19], s44 offen offset:0 nt
    buffer_load_dwordx4 v[180:183], v2, s[16:19], s44 offen offset:1024 nt
    buffer_load_dwordx4 v[184:187], v2, s[16:19], s44 offen offset:2048 nt
    buffer_load_dwordx4 v[188:191], v2, s[16:19], s44 offen offset:3072 nt
    s_add_u32 s44, s44, 16384
    s_getreg_b32 s40, hwreg(HW_REG_XCC_ID, 0, 4)
    s_or_b32 s40, s40, 16
    s_lshl_b32 s36, s38, 1
    v_mov_b32 v12, s36
    s_mov_b32 s54, s53
    s_mov_b32 s55, s53
    s_cmp_gt_u32 s37, 3
    s_subb_u32 s46, s37, 0
    s_lshl_b32 s47, s46, 9
    s_add_u32 s47, s47, s53
    s_lshl_b32 s48, s46, 3
    s_add_u32 s48, s48, s53
    s_lshl_b32 s63, s3, 2
    v_add_u32 v11, s63, v10
    s_mov_b32 s60, 0x05040100
    s_mov_b32 s61, 0x07060302
    s_mov_b32 s62, 0x3fb8aa3b
    s_mov_b32 s10, 0x3db504f3
    s_mov_b32 s11, s10
    s_mov_b32 s43, -2
    s_lshl_b32 s52, s3, 8
    s_add_u32 s52, s52, s39
    s_waitcnt vmcnt(16)
    buffer_load_dwordx4 v[192:195], v2, s[16:19], s44 offen offset:0 nt
    buffer_load_dwordx4 v[196:199], v2, s[16:19], s44 offen offset:1024 nt
    buffer_load_dwordx4 v[200:203], v2, s[16:19], s44 offen offset:2048 nt
    buffer_load_dwordx4 v[204:207], v2, s[16:19], s44 offen offset:3072 nt
    s_add_u32 s44, s44, 16384
    v_mfma_f32_16x16x32_bf16 v[80:83], v[112:115], v[16:19], 0
    v_mfma_f32_16x16x32_bf16 v[84:87], v[116:119], v[16:19], 0
    v_mfma_f32_16x16x32_bf16 v[88:91], v[120:123], v[16:19], 0
    v_mfma_f32_16x16x32_bf16 v[92:95], v[124:127], v[16:19], 0
    s_waitcnt vmcnt(16)
    buffer_load_dwordx4 v[112:115], v2, s[16:19], s44 offen offset:0 nt
    buffer_load_dwordx4 v[116:119], v2, s[16:19], s44 offen offset:1024 nt
    buffer_load_dwordx4 v[120:123], v2, s[16:19], s44 offen offset:2048 nt
    buffer_load_dwordx4 v[124:127], v2, s[16:19], s44 offen offset:3072 nt
    s_add_u32 s44, s44, 16384
    v_mfma_f32_16x16x32_bf16 v[96:99], v[128:131], v[16:19], 0
    v_mfma_f32_16x16x32_bf16 v[100:103], v[132:135], v[16:19], 0
    v_mfma_f32_16x16x32_bf16 v[104:107], v[136:139], v[16:19], 0
    v_mfma_f32_16x16x32_bf16 v[108:111], v[140:143], v[16:19], 0
    v_add_f32_dpp v80, v81, v80 row_shl:4 row_mask:0xf bank_mask:0x1
    v_add_f32_dpp v84, v85, v84 row_shl:4 row_mask:0xf bank_mask:0x1
    v_add_f32_dpp v88, v89, v88 row_shl:4 row_mask:0xf bank_mask:0x1
    v_add_f32_dpp v92, v93, v92 row_shl:4 row_mask:0xf bank_mask:0x1
    v_add_f32_dpp v80, v82, v80 row_shl:8 row_mask:0xf bank_mask:0x1
    v_add_f32_dpp v84, v86, v84 row_shl:8 row_mask:0xf bank_mask:0x1
    v_add_f32_dpp v88, v90, v88 row_shl:8 row_mask:0xf bank_mask:0x1
    v_add_f32_dpp v92, v94, v92 row_shl:8 row_mask:0xf bank_mask:0x1
    v_add_f32_dpp v40, v83, v80 row_shl:12 row_mask:0xf bank_mask:0x1
    v_add_f32_dpp v41, v87, v84 row_shl:12 row_mask:0xf bank_mask:0x1
    v_add_f32_dpp v42, v91, v88 row_shl:12 row_mask:0xf bank_mask:0x1
    v_add_f32_dpp v43, v95, v92 row_shl:12 row_mask:0xf bank_mask:0x1
    s_waitcnt vmcnt(16)
    buffer_load_dwordx4 v[128:131], v2, s[16:19], s44 offen offset:0 nt
    buffer_load_dwordx4 v[132:135], v2, s[16:19], s44 offen offset:1024 nt
    buffer_load_dwordx4 v[136:139], v2, s[16:19], s44 offen offset:2048 nt
    buffer_load_dwordx4 v[140:143], v2, s[16:19], s44 offen offset:3072 nt
    s_add_u32 s44, s44, 16384
    v_mfma_f32_16x16x32_bf16 v[80:83], v[144:147], v[16:19], 0
    v_mfma_f32_16x16x32_bf16 v[84:87], v[148:151], v[16:19], 0
    v_mfma_f32_16x16x32_bf16 v[88:91], v[152:155], v[16:19], 0
    v_mfma_f32_16x16x32_bf16 v[92:95], v[156:159], v[16:19], 0
    v_add_f32_dpp v97, v96, v97 row_shr:4 row_mask:0xf bank_mask:0x2
    v_add_f32_dpp v101, v100, v101 row_shr:4 row_mask:0xf bank_mask:0x2
    v_add_f32_dpp v105, v104, v105 row_shr:4 row_mask:0xf bank_mask:0x2
    v_add_f32_dpp v109, v108, v109 row_shr:4 row_mask:0xf bank_mask:0x2
    v_add_f32_dpp v97, v98, v97 row_shl:4 row_mask:0xf bank_mask:0x2
    v_add_f32_dpp v101, v102, v101 row_shl:4 row_mask:0xf bank_mask:0x2
    v_add_f32_dpp v105, v106, v105 row_shl:4 row_mask:0xf bank_mask:0x2
    v_add_f32_dpp v109, v110, v109 row_shl:4 row_mask:0xf bank_mask:0x2
    v_add_f32_dpp v40, v99, v97 row_shl:8 row_mask:0xf bank_mask:0x2
    v_add_f32_dpp v41, v103, v101 row_shl:8 row_mask:0xf bank_mask:0x2
    v_add_f32_dpp v42, v107, v105 row_shl:8 row_mask:0xf bank_mask:0x2
    v_add_f32_dpp v43, v111, v109 row_shl:8 row_mask:0xf bank_mask:0x2
    s_cmp_lg_u32 s37, 3
    s_cbranch_scc1 L_nosig
    s_barrier
    s_cmp_lg_u32 s3, 0
    s_cbranch_scc1 L_nosig
    s_mov_b64 exec, 1
    v_mov_b32 v5, s40
    global_store_short v12, v5, s[12:13]
    s_mov_b64 exec, -1
L_nosig:
    s_waitcnt vmcnt(16)
    buffer_load_dwordx4 v[144:147], v2, s[16:19], s44 offen offset:0 nt
    buffer_load_dwordx4 v[148:151], v2, s[16:19], s44 offen offset:1024 nt
    buffer_load_dwordx4 v[152:155], v2, s[16:19], s44 offen offset:2048 nt
    buffer_load_dwordx4 v[156:159], v2, s[16:19], s44 offen offset:3072 nt
    s_add_u32 s44, s44, 16384
    v_mfma_f32_16x16x32_bf16 v[96:99], v[160:163], v[16:19], 0
    v_mfma_f32_16x16x32_bf16 v[100:103], v[164:167], v[16:19], 0
    v_mfma_f32_16x16x32_bf16 v[104:107], v[168:171], v[16:19], 0
    v_mfma_f32_16x16x32_bf16 v[108:111], v[172:175], v[16:19], 0
    v_add_f32_dpp v82, v80, v82 row_shr:8 row_mask:0xf bank_mask:0x4
    v_add_f32_dpp v86, v84, v86 row_shr:8 row_mask:0xf bank_mask:0x4
    v_add_f32_dpp v90, v88, v90 row_shr:8 row_mask:0xf bank_mask:0x4
    v_add_f32_dpp v94, v92, v94 row_shr:8 row_mask:0xf bank_mask:0x4
    v_add_f32_dpp v82, v81, v82 row_shr:4 row_mask:0xf bank_mask:0x4
    v_add_f32_dpp v86, v85, v86 row_shr:4 row_mask:0xf bank_mask:0x4
    v_add_f32_dpp v90, v89, v90 row_shr:4 row_mask:0xf bank_mask:0x4
    v_add_f32_dpp v94, v93, v94 row_shr:4 row_mask:0xf bank_mask:0x4
    v_add_f32_dpp v40, v83, v82 row_shl:4 row_mask:0xf bank_mask:0x4
    v_add_f32_dpp v41, v87, v86 row_shl:4 row_mask:0xf bank_mask:0x4
    v_add_f32_dpp v42, v91, v90 row_shl:4 row_mask:0xf bank_mask:0x4
    v_add_f32_dpp v43, v95, v94 row_shl:4 row_mask:0xf bank_mask:0x4
    s_waitcnt vmcnt(16)
    buffer_load_dwordx4 v[160:163], v2, s[16:19], s44 offen offset:0 nt
    buffer_load_dwordx4 v[164:167], v2, s[16:19], s44 offen offset:1024 nt
    buffer_load_dwordx4 v[168:171], v2, s[16:19], s44 offen offset:2048 nt
    buffer_load_dwordx4 v[172:175], v2, s[16:19], s44 offen offset:3072 nt
    s_add_u32 s44, s44, 16384
    v_mfma_f32_16x16x32_bf16 v[80:83], v[176:179], v[16:19], 0
    v_mfma_f32_16x16x32_bf16 v[84:87], v[180:183], v[16:19], 0
    v_mfma_f32_16x16x32_bf16 v[88:91], v[184:187], v[16:19], 0
    v_mfma_f32_16x16x32_bf16 v[92:95], v[188:191], v[16:19], 0
    v_add_f32_dpp v99, v96, v99 row_shr:12 row_mask:0xf bank_mask:0x8
    v_add_f32_dpp v103, v100, v103 row_shr:12 row_mask:0xf bank_mask:0x8
    v_add_f32_dpp v107, v104, v107 row_shr:12 row_mask:0xf bank_mask:0x8
    v_add_f32_dpp v111, v108, v111 row_shr:12 row_mask:0xf bank_mask:0x8
    v_add_f32_dpp v99, v97, v99 row_shr:8 row_mask:0xf bank_mask:0x8
    v_add_f32_dpp v103, v101, v103 row_shr:8 row_mask:0xf bank_mask:0x8
    v_add_f32_dpp v107, v105, v107 row_shr:8 row_mask:0xf bank_mask:0x8
    v_add_f32_dpp v111, v109, v111 row_shr:8 row_mask:0xf bank_mask:0x8
    v_add_f32_dpp v40, v98, v99 row_shr:4 row_mask:0xf bank_mask:0x8
    v_add_f32_dpp v41, v102, v103 row_shr:4 row_mask:0xf bank_mask:0x8
    v_add_f32_dpp v42, v106, v107 row_shr:4 row_mask:0xf bank_mask:0x8
    v_add_f32_dpp v43, v110, v111 row_shr:4 row_mask:0xf bank_mask:0x8
    v_cvt_pk_bf16_f32 v41, v40, v41
    v_cvt_pk_bf16_f32 v43, v42, v43
    v_lshlrev_b32 v40, 16, v41
    v_lshlrev_b32 v42, 16, v43
    v_and_b32 v41, 0xffff0000, v41
    v_and_b32 v43, 0xffff0000, v43
    v_pk_mul_f32 v[40:41], v[40:41], s[10:11]
    v_pk_mul_f32 v[42:43], v[42:43], s[10:11]
    v_cvt_pk_bf16_f32 v41, v40, v41
    v_cvt_pk_bf16_f32 v43, v42, v43
    v_lshlrev_b32 v40, 16, v41
    v_lshlrev_b32 v42, 16, v43
    v_and_b32 v41, 0xffff0000, v41
    v_and_b32 v43, 0xffff0000, v43
    s_waitcnt vmcnt(16)
    buffer_load_dwordx4 v[176:179], v2, s[16:19], s44 offen offset:0 nt
    buffer_load_dwordx4 v[180:183], v2, s[16:19], s44 offen offset:1024 nt
    buffer_load_dwordx4 v[184:187], v2, s[16:19], s44 offen offset:2048 nt
    buffer_load_dwordx4 v[188:191], v2, s[16:19], s44 offen offset:3072 nt
    s_add_u32 s44, s44, 16384
    v_mfma_f32_16x16x32_bf16 v[96:99], v[192:195], v[16:19], 0
    v_mfma_f32_16x16x32_bf16 v[100:103], v[196:199], v[16:19], 0
    v_mfma_f32_16x16x32_bf16 v[104:107], v[200:203], v[16:19], 0
    v_mfma_f32_16x16x32_bf16 v[108:111], v[204:207], v[16:19], 0
    v_add_f32_dpp v80, v81, v80 row_shl:4 row_mask:0xf bank_mask:0x1
    v_add_f32_dpp v84, v85, v84 row_shl:4 row_mask:0xf bank_mask:0x1
    v_add_f32_dpp v88, v89, v88 row_shl:4 row_mask:0xf bank_mask:0x1
    v_add_f32_dpp v92, v93, v92 row_shl:4 row_mask:0xf bank_mask:0x1
    v_add_f32_dpp v80, v82, v80 row_shl:8 row_mask:0xf bank_mask:0x1
    v_add_f32_dpp v84, v86, v84 row_shl:8 row_mask:0xf bank_mask:0x1
    v_add_f32_dpp v88, v90, v88 row_shl:8 row_mask:0xf bank_mask:0x1
    v_add_f32_dpp v92, v94, v92 row_shl:8 row_mask:0xf bank_mask:0x1
    v_add_f32_dpp v44, v83, v80 row_shl:12 row_mask:0xf bank_mask:0x1
    v_add_f32_dpp v45, v87, v84 row_shl:12 row_mask:0xf bank_mask:0x1
    v_add_f32_dpp v46, v91, v88 row_shl:12 row_mask:0xf bank_mask:0x1
    v_add_f32_dpp v47, v95, v92 row_shl:12 row_mask:0xf bank_mask:0x1
    s_waitcnt vmcnt(16)
    buffer_load_dwordx4 v[192:195], v2, s[16:19], s44 offen offset:0 nt
    buffer_load_dwordx4 v[196:199], v2, s[16:19], s44 offen offset:1024 nt
    buffer_load_dwordx4 v[200:203], v2, s[16:19], s44 offen offset:2048 nt
    buffer_load_dwordx4 v[204:207], v2, s[16:19], s44 offen offset:3072 nt
    s_add_u32 s44, s44, 16384
    v_mfma_f32_16x16x32_bf16 v[80:83], v[112:115], v[16:19], 0
    v_mfma_f32_16x16x32_bf16 v[84:87], v[116:119], v[16:19], 0
    v_mfma_f32_16x16x32_bf16 v[88:91], v[120:123], v[16:19], 0
    v_mfma_f32_16x16x32_bf16 v[92:95], v[124:127], v[16:19], 0
    v_add_f32_dpp v97, v96, v97 row_shr:4 row_mask:0xf bank_mask:0x2
    v_add_f32_dpp v101, v100, v101 row_shr:4 row_mask:0xf bank_mask:0x2
    v_add_f32_dpp v105, v104, v105 row_shr:4 row_mask:0xf bank_mask:0x2
    v_add_f32_dpp v109, v108, v109 row_shr:4 row_mask:0xf bank_mask:0x2
    v_add_f32_dpp v97, v98, v97 row_shl:4 row_mask:0xf bank_mask:0x2
    v_add_f32_dpp v101, v102, v101 row_shl:4 row_mask:0xf bank_mask:0x2
    v_add_f32_dpp v105, v106, v105 row_shl:4 row_mask:0xf bank_mask:0x2
    v_add_f32_dpp v109, v110, v109 row_shl:4 row_mask:0xf bank_mask:0x2
    v_add_f32_dpp v44, v99, v97 row_shl:8 row_mask:0xf bank_mask:0x2
    v_add_f32_dpp v45, v103, v101 row_shl:8 row_mask:0xf bank_mask:0x2
    v_add_f32_dpp v46, v107, v105 row_shl:8 row_mask:0xf bank_mask:0x2
    v_add_f32_dpp v47, v111, v109 row_shl:8 row_mask:0xf bank_mask:0x2
    s_waitcnt vmcnt(16)
    buffer_load_dwordx4 v[112:115], v2, s[16:19], s44 offen offset:0 nt
    buffer_load_dwordx4 v[116:119], v2, s[16:19], s44 offen offset:1024 nt
    buffer_load_dwordx4 v[120:123], v2, s[16:19], s44 offen offset:2048 nt
    buffer_load_dwordx4 v[124:127], v2, s[16:19], s44 offen offset:3072 nt
    s_add_u32 s44, s44, 16384
    v_mfma_f32_16x16x32_bf16 v[96:99], v[128:131], v[16:19], 0
    v_mfma_f32_16x16x32_bf16 v[100:103], v[132:135], v[16:19], 0
    v_mfma_f32_16x16x32_bf16 v[104:107], v[136:139], v[16:19], 0
    v_mfma_f32_16x16x32_bf16 v[108:111], v[140:143], v[16:19], 0
    v_add_f32_dpp v82, v80, v82 row_shr:8 row_mask:0xf bank_mask:0x4
    v_add_f32_dpp v86, v84, v86 row_shr:8 row_mask:0xf bank_mask:0x4
    v_add_f32_dpp v90, v88, v90 row_shr:8 row_mask:0xf bank_mask:0x4
    v_add_f32_dpp v94, v92, v94 row_shr:8 row_mask:0xf bank_mask:0x4
    v_add_f32_dpp v82, v81, v82 row_shr:4 row_mask:0xf bank_mask:0x4
    v_add_f32_dpp v86, v85, v86 row_shr:4 row_mask:0xf bank_mask:0x4
    v_add_f32_dpp v90, v89, v90 row_shr:4 row_mask:0xf bank_mask:0x4
    v_add_f32_dpp v94, v93, v94 row_shr:4 row_mask:0xf bank_mask:0x4
    v_add_f32_dpp v44, v83, v82 row_shl:4 row_mask:0xf bank_mask:0x4
    v_add_f32_dpp v45, v87, v86 row_shl:4 row_mask:0xf bank_mask:0x4
    v_add_f32_dpp v46, v91, v90 row_shl:4 row_mask:0xf bank_mask:0x4
    v_add_f32_dpp v47, v95, v94 row_shl:4 row_mask:0xf bank_mask:0x4
    s_waitcnt vmcnt(16)
    buffer_load_dwordx4 v[128:131], v2, s[16:19], s44 offen offset:0 nt
    buffer_load_dwordx4 v[132:135], v2, s[16:19], s44 offen offset:1024 nt
    buffer_load_dwordx4 v[136:139], v2, s[16:19], s44 offen offset:2048 nt
    buffer_load_dwordx4 v[140:143], v2, s[16:19], s44 offen offset:3072 nt
    s_add_u32 s44, s44, 16384
    v_mfma_f32_16x16x32_bf16 v[80:83], v[144:147], v[16:19], 0
    v_mfma_f32_16x16x32_bf16 v[84:87], v[148:151], v[16:19], 0
    v_mfma_f32_16x16x32_bf16 v[88:91], v[152:155], v[16:19], 0
    v_mfma_f32_16x16x32_bf16 v[92:95], v[156:159], v[16:19], 0
    v_add_f32_dpp v99, v96, v99 row_shr:12 row_mask:0xf bank_mask:0x8
    v_add_f32_dpp v103, v100, v103 row_shr:12 row_mask:0xf bank_mask:0x8
    v_add_f32_dpp v107, v104, v107 row_shr:12 row_mask:0xf bank_mask:0x8
    v_add_f32_dpp v111, v108, v111 row_shr:12 row_mask:0xf bank_mask:0x8
    v_add_f32_dpp v99, v97, v99 row_shr:8 row_mask:0xf bank_mask:0x8
    v_add_f32_dpp v103, v101, v103 row_shr:8 row_mask:0xf bank_mask:0x8
    v_add_f32_dpp v107, v105, v107 row_shr:8 row_mask:0xf bank_mask:0x8
    v_add_f32_dpp v111, v109, v111 row_shr:8 row_mask:0xf bank_mask:0x8
    v_add_f32_dpp v44, v98, v99 row_shr:4 row_mask:0xf bank_mask:0x8
    v_add_f32_dpp v45, v102, v103 row_shr:4 row_mask:0xf bank_mask:0x8
    v_add_f32_dpp v46, v106, v107 row_shr:4 row_mask:0xf bank_mask:0x8
    v_add_f32_dpp v47, v110, v111 row_shr:4 row_mask:0xf bank_mask:0x8
    v_cvt_pk_bf16_f32 v45, v44, v45
    v_cvt_pk_bf16_f32 v47, v46, v47
    v_lshlrev_b32 v44, 16, v45
    v_lshlrev_b32 v46, 16, v47
    v_and_b32 v45, 0xffff0000, v45
    v_and_b32 v47, 0xffff0000, v47
    v_pk_mul_f32 v[44:45], v[44:45], s[10:11]
    v_pk_mul_f32 v[46:47], v[46:47], s[10:11]
    v_cvt_pk_bf16_f32 v45, v44, v45
    v_cvt_pk_bf16_f32 v47, v46, v47
    v_lshlrev_b32 v44, 16, v45
    v_lshlrev_b32 v46, 16, v47
    v_and_b32 v45, 0xffff0000, v45
    v_and_b32 v47, 0xffff0000, v47
    s_waitcnt vmcnt(16)
    buffer_load_dwordx4 v[144:147], v2, s[16:19], s44 offen offset:0 nt
    buffer_load_dwordx4 v[148:151], v2, s[16:19], s44 offen offset:1024 nt
    buffer_load_dwordx4 v[152:155], v2, s[16:19], s44 offen offset:2048 nt
    buffer_load_dwordx4 v[156:159], v2, s[16:19], s44 offen offset:3072 nt
    s_add_u32 s44, s44, 16384
    v_mfma_f32_16x16x32_bf16 v[96:99], v[160:163], v[16:19], 0
    v_mfma_f32_16x16x32_bf16 v[100:103], v[164:167], v[16:19], 0
    v_mfma_f32_16x16x32_bf16 v[104:107], v[168:171], v[16:19], 0
    v_mfma_f32_16x16x32_bf16 v[108:111], v[172:175], v[16:19], 0
    v_add_f32_dpp v80, v81, v80 row_shl:4 row_mask:0xf bank_mask:0x1
    v_add_f32_dpp v84, v85, v84 row_shl:4 row_mask:0xf bank_mask:0x1
    v_add_f32_dpp v88, v89, v88 row_shl:4 row_mask:0xf bank_mask:0x1
    v_add_f32_dpp v92, v93, v92 row_shl:4 row_mask:0xf bank_mask:0x1
    v_add_f32_dpp v80, v82, v80 row_shl:8 row_mask:0xf bank_mask:0x1
    v_add_f32_dpp v84, v86, v84 row_shl:8 row_mask:0xf bank_mask:0x1
    v_add_f32_dpp v88, v90, v88 row_shl:8 row_mask:0xf bank_mask:0x1
    v_add_f32_dpp v92, v94, v92 row_shl:8 row_mask:0xf bank_mask:0x1
    v_add_f32_dpp v48, v83, v80 row_shl:12 row_mask:0xf bank_mask:0x1
    v_add_f32_dpp v49, v87, v84 row_shl:12 row_mask:0xf bank_mask:0x1
    v_add_f32_dpp v50, v91, v88 row_shl:12 row_mask:0xf bank_mask:0x1
    v_add_f32_dpp v51, v95, v92 row_shl:12 row_mask:0xf bank_mask:0x1
    s_waitcnt vmcnt(16)
    global_load_ushort v14, v12, s[12:13] sc1
    buffer_load_dwordx4 v[160:163], v2, s[16:19], s44 offen offset:0 nt
    buffer_load_dwordx4 v[164:167], v2, s[16:19], s44 offen offset:1024 nt
    buffer_load_dwordx4 v[168:171], v2, s[16:19], s44 offen offset:2048 nt
    buffer_load_dwordx4 v[172:175], v2, s[16:19], s44 offen offset:3072 nt
    v_mfma_f32_16x16x32_bf16 v[80:83], v[176:179], v[16:19], 0
    v_mfma_f32_16x16x32_bf16 v[84:87], v[180:183], v[16:19], 0
    v_mfma_f32_16x16x32_bf16 v[88:91], v[184:187], v[16:19], 0
    v_mfma_f32_16x16x32_bf16 v[92:95], v[188:191], v[16:19], 0
    v_add_f32_dpp v97, v96, v97 row_shr:4 row_mask:0xf bank_mask:0x2
    v_add_f32_dpp v101, v100, v101 row_shr:4 row_mask:0xf bank_mask:0x2
    v_add_f32_dpp v105, v104, v105 row_shr:4 row_mask:0xf bank_mask:0x2
    v_add_f32_dpp v109, v108, v109 row_shr:4 row_mask:0xf bank_mask:0x2
    v_add_f32_dpp v97, v98, v97 row_shl:4 row_mask:0xf bank_mask:0x2
    v_add_f32_dpp v101, v102, v101 row_shl:4 row_mask:0xf bank_mask:0x2
    v_add_f32_dpp v105, v106, v105 row_shl:4 row_mask:0xf bank_mask:0x2
    v_add_f32_dpp v109, v110, v109 row_shl:4 row_mask:0xf bank_mask:0x2
    v_add_f32_dpp v48, v99, v97 row_shl:8 row_mask:0xf bank_mask:0x2
    v_add_f32_dpp v49, v103, v101 row_shl:8 row_mask:0xf bank_mask:0x2
    v_add_f32_dpp v50, v107, v105 row_shl:8 row_mask:0xf bank_mask:0x2
    v_add_f32_dpp v51, v111, v109 row_shl:8 row_mask:0xf bank_mask:0x2
    s_waitcnt vmcnt(17)
    buffer_load_dwordx4 v[176:179], v3, s[20:23], s45 offen offset:0 nt
    buffer_load_dwordx4 v[180:183], v3, s[20:23], s45 offen offset:1024 nt
    buffer_load_dwordx4 v[184:187], v3, s[20:23], s45 offen offset:2048 nt
    buffer_load_dwordx4 v[188:191], v3, s[20:23], s45 offen offset:3072 nt
    s_add_u32 s45, s45, 16384
    v_mfma_f32_16x16x32_bf16 v[96:99], v[192:195], v[16:19], 0
    v_mfma_f32_16x16x32_bf16 v[100:103], v[196:199], v[16:19], 0
    v_mfma_f32_16x16x32_bf16 v[104:107], v[200:203], v[16:19], 0
    v_mfma_f32_16x16x32_bf16 v[108:111], v[204:207], v[16:19], 0
    v_add_f32_dpp v82, v80, v82 row_shr:8 row_mask:0xf bank_mask:0x4
    v_add_f32_dpp v86, v84, v86 row_shr:8 row_mask:0xf bank_mask:0x4
    v_add_f32_dpp v90, v88, v90 row_shr:8 row_mask:0xf bank_mask:0x4
    v_add_f32_dpp v94, v92, v94 row_shr:8 row_mask:0xf bank_mask:0x4
    v_add_f32_dpp v82, v81, v82 row_shr:4 row_mask:0xf bank_mask:0x4
    v_add_f32_dpp v86, v85, v86 row_shr:4 row_mask:0xf bank_mask:0x4
    v_add_f32_dpp v90, v89, v90 row_shr:4 row_mask:0xf bank_mask:0x4
    v_add_f32_dpp v94, v93, v94 row_shr:4 row_mask:0xf bank_mask:0x4
    v_add_f32_dpp v48, v83, v82 row_shl:4 row_mask:0xf bank_mask:0x4
    v_add_f32_dpp v49, v87, v86 row_shl:4 row_mask:0xf bank_mask:0x4
    v_add_f32_dpp v50, v91, v90 row_shl:4 row_mask:0xf bank_mask:0x4
    v_add_f32_dpp v51, v95, v94 row_shl:4 row_mask:0xf bank_mask:0x4
    s_waitcnt vmcnt(17)
    buffer_load_dwordx4 v[192:195], v3, s[20:23], s45 offen offset:0 nt
    buffer_load_dwordx4 v[196:199], v3, s[20:23], s45 offen offset:1024 nt
    buffer_load_dwordx4 v[200:203], v3, s[20:23], s45 offen offset:2048 nt
    buffer_load_dwordx4 v[204:207], v3, s[20:23], s45 offen offset:3072 nt
    s_add_u32 s45, s45, 16384
    v_mfma_f32_16x16x32_bf16 v[80:83], v[112:115], v[16:19], 0
    v_mfma_f32_16x16x32_bf16 v[84:87], v[116:119], v[16:19], 0
    v_mfma_f32_16x16x32_bf16 v[88:91], v[120:123], v[16:19], 0
    v_mfma_f32_16x16x32_bf16 v[92:95], v[124:127], v[16:19], 0
    v_add_f32_dpp v99, v96, v99 row_shr:12 row_mask:0xf bank_mask:0x8
    v_add_f32_dpp v103, v100, v103 row_shr:12 row_mask:0xf bank_mask:0x8
    v_add_f32_dpp v107, v104, v107 row_shr:12 row_mask:0xf bank_mask:0x8
    v_add_f32_dpp v111, v108, v111 row_shr:12 row_mask:0xf bank_mask:0x8
    v_add_f32_dpp v99, v97, v99 row_shr:8 row_mask:0xf bank_mask:0x8
    v_add_f32_dpp v103, v101, v103 row_shr:8 row_mask:0xf bank_mask:0x8
    v_add_f32_dpp v107, v105, v107 row_shr:8 row_mask:0xf bank_mask:0x8
    v_add_f32_dpp v111, v109, v111 row_shr:8 row_mask:0xf bank_mask:0x8
    v_add_f32_dpp v48, v98, v99 row_shr:4 row_mask:0xf bank_mask:0x8
    v_add_f32_dpp v49, v102, v103 row_shr:4 row_mask:0xf bank_mask:0x8
    v_add_f32_dpp v50, v106, v107 row_shr:4 row_mask:0xf bank_mask:0x8
    v_add_f32_dpp v51, v110, v111 row_shr:4 row_mask:0xf bank_mask:0x8
    v_cvt_pk_bf16_f32 v49, v48, v49
    v_cvt_pk_bf16_f32 v51, v50, v51
    v_lshlrev_b32 v48, 16, v49
    v_lshlrev_b32 v50, 16, v51
    v_and_b32 v49, 0xffff0000, v49
    v_and_b32 v51, 0xffff0000, v51
    v_pk_mul_f32 v[48:49], v[48:49], s[10:11]
    v_pk_mul_f32 v[50:51], v[50:51], s[10:11]
    v_cvt_pk_bf16_f32 v49, v48, v49
    v_cvt_pk_bf16_f32 v51, v50, v51
    v_lshlrev_b32 v48, 16, v49
    v_lshlrev_b32 v50, 16, v51
    v_and_b32 v49, 0xffff0000, v49
    v_and_b32 v51, 0xffff0000, v51
    s_waitcnt vmcnt(17)
    buffer_load_dwordx4 v[112:115], v3, s[20:23], s45 offen offset:0 nt
    buffer_load_dwordx4 v[116:119], v3, s[20:23], s45 offen offset:1024 nt
    buffer_load_dwordx4 v[120:123], v3, s[20:23], s45 offen offset:2048 nt
    buffer_load_dwordx4 v[124:127], v3, s[20:23], s45 offen offset:3072 nt
    s_add_u32 s45, s45, 16384
    v_mfma_f32_16x16x32_bf16 v[96:99], v[128:131], v[16:19], 0
    v_mfma_f32_16x16x32_bf16 v[100:103], v[132:135], v[16:19], 0
    v_mfma_f32_16x16x32_bf16 v[104:107], v[136:139], v[16:19], 0
    v_mfma_f32_16x16x32_bf16 v[108:111], v[140:143], v[16:19], 0
    v_add_f32_dpp v80, v81, v80 row_shl:4 row_mask:0xf bank_mask:0x1
    v_add_f32_dpp v84, v85, v84 row_shl:4 row_mask:0xf bank_mask:0x1
    v_add_f32_dpp v88, v89, v88 row_shl:4 row_mask:0xf bank_mask:0x1
    v_add_f32_dpp v92, v93, v92 row_shl:4 row_mask:0xf bank_mask:0x1
    v_add_f32_dpp v80, v82, v80 row_shl:8 row_mask:0xf bank_mask:0x1
    v_add_f32_dpp v84, v86, v84 row_shl:8 row_mask:0xf bank_mask:0x1
    v_add_f32_dpp v88, v90, v88 row_shl:8 row_mask:0xf bank_mask:0x1
    v_add_f32_dpp v92, v94, v92 row_shl:8 row_mask:0xf bank_mask:0x1
    v_add_f32_dpp v52, v83, v80 row_shl:12 row_mask:0xf bank_mask:0x1
    v_add_f32_dpp v53, v87, v84 row_shl:12 row_mask:0xf bank_mask:0x1
    v_add_f32_dpp v54, v91, v88 row_shl:12 row_mask:0xf bank_mask:0x1
    v_add_f32_dpp v55, v95, v92 row_shl:12 row_mask:0xf bank_mask:0x1
    s_waitcnt vmcnt(17)
    buffer_load_dwordx4 v[128:131], v3, s[20:23], s45 offen offset:0 nt
    buffer_load_dwordx4 v[132:135], v3, s[20:23], s45 offen offset:1024 nt
    buffer_load_dwordx4 v[136:139], v3, s[20:23], s45 offen offset:2048 nt
    buffer_load_dwordx4 v[140:143], v3, s[20:23], s45 offen offset:3072 nt
    s_add_u32 s45, s45, 16384
    v_mfma_f32_16x16x32_bf16 v[80:83], v[144:147], v[16:19], 0
    v_mfma_f32_16x16x32_bf16 v[84:87], v[148:151], v[16:19], 0
    v_mfma_f32_16x16x32_bf16 v[88:91], v[152:155], v[16:19], 0
    v_mfma_f32_16x16x32_bf16 v[92:95], v[156:159], v[16:19], 0
    v_add_f32_dpp v97, v96, v97 row_shr:4 row_mask:0xf bank_mask:0x2
    v_add_f32_dpp v101, v100, v101 row_shr:4 row_mask:0xf bank_mask:0x2
    v_add_f32_dpp v105, v104, v105 row_shr:4 row_mask:0xf bank_mask:0x2
    v_add_f32_dpp v109, v108, v109 row_shr:4 row_mask:0xf bank_mask:0x2
    v_add_f32_dpp v97, v98, v97 row_shl:4 row_mask:0xf bank_mask:0x2
    v_add_f32_dpp v101, v102, v101 row_shl:4 row_mask:0xf bank_mask:0x2
    v_add_f32_dpp v105, v106, v105 row_shl:4 row_mask:0xf bank_mask:0x2
    v_add_f32_dpp v109, v110, v109 row_shl:4 row_mask:0xf bank_mask:0x2
    v_add_f32_dpp v52, v99, v97 row_shl:8 row_mask:0xf bank_mask:0x2
    v_add_f32_dpp v53, v103, v101 row_shl:8 row_mask:0xf bank_mask:0x2
    v_add_f32_dpp v54, v107, v105 row_shl:8 row_mask:0xf bank_mask:0x2
    v_add_f32_dpp v55, v111, v109 row_shl:8 row_mask:0xf bank_mask:0x2
    s_waitcnt vmcnt(16)
    buffer_load_dwordx4 v[144:147], v3, s[20:23], s45 offen offset:0 nt
    buffer_load_dwordx4 v[148:151], v3, s[20:23], s45 offen offset:1024 nt
    buffer_load_dwordx4 v[152:155], v3, s[20:23], s45 offen offset:2048 nt
    buffer_load_dwordx4 v[156:159], v3, s[20:23], s45 offen offset:3072 nt
    s_add_u32 s45, s45, 16384
    v_mfma_f32_16x16x32_bf16 v[96:99], v[160:163], v[16:19], 0
    v_mfma_f32_16x16x32_bf16 v[100:103], v[164:167], v[16:19], 0
    v_mfma_f32_16x16x32_bf16 v[104:107], v[168:171], v[16:19], 0
    v_mfma_f32_16x16x32_bf16 v[108:111], v[172:175], v[16:19], 0
    v_add_f32_dpp v82, v80, v82 row_shr:8 row_mask:0xf bank_mask:0x4
    v_add_f32_dpp v86, v84, v86 row_shr:8 row_mask:0xf bank_mask:0x4
    v_add_f32_dpp v90, v88, v90 row_shr:8 row_mask:0xf bank_mask:0x4
    v_add_f32_dpp v94, v92, v94 row_shr:8 row_mask:0xf bank_mask:0x4
    v_add_f32_dpp v82, v81, v82 row_shr:4 row_mask:0xf bank_mask:0x4
    v_add_f32_dpp v86, v85, v86 row_shr:4 row_mask:0xf bank_mask:0x4
    v_add_f32_dpp v90, v89, v90 row_shr:4 row_mask:0xf bank_mask:0x4
    v_add_f32_dpp v94, v93, v94 row_shr:4 row_mask:0xf bank_mask:0x4
    v_add_f32_dpp v52, v83, v82 row_shl:4 row_mask:0xf bank_mask:0x4
    v_add_f32_dpp v53, v87, v86 row_shl:4 row_mask:0xf bank_mask:0x4
    v_add_f32_dpp v54, v91, v90 row_shl:4 row_mask:0xf bank_mask:0x4
    v_add_f32_dpp v55, v95, v94 row_shl:4 row_mask:0xf bank_mask:0x4
    v_mov_b32 v64, 0
    v_mov_b32 v65, 0
    v_mov_b32 v66, 0
    v_mov_b32 v67, 0
    v_mov_b32 v68, 0
    v_mov_b32 v69, 0
    v_mov_b32 v70, 0
    v_mov_b32 v71, 0
    v_mov_b32 v72, 0
    v_mov_b32 v73, 0
    v_mov_b32 v74, 0
    v_mov_b32 v75, 0
    v_mov_b32 v76, 0
    v_mov_b32 v77, 0
    v_mov_b32 v78, 0
    v_mov_b32 v79, 0
    v_add_f32_dpp v99, v96, v99 row_shr:12 row_mask:0xf bank_mask:0x8
    v_add_f32_dpp v103, v100, v103 row_shr:12 row_mask:0xf bank_mask:0x8
    v_add_f32_dpp v107, v104, v107 row_shr:12 row_mask:0xf bank_mask:0x8
    v_add_f32_dpp v111, v108, v111 row_shr:12 row_mask:0xf bank_mask:0x8
    v_add_f32_dpp v99, v97, v99 row_shr:8 row_mask:0xf bank_mask:0x8
    v_add_f32_dpp v103, v101, v103 row_shr:8 row_mask:0xf bank_mask:0x8
    v_add_f32_dpp v107, v105, v107 row_shr:8 row_mask:0xf bank_mask:0x8
    v_add_f32_dpp v111, v109, v111 row_shr:8 row_mask:0xf bank_mask:0x8
    v_add_f32_dpp v52, v98, v99 row_shr:4 row_mask:0xf bank_mask:0x8
    v_add_f32_dpp v53, v102, v103 row_shr:4 row_mask:0xf bank_mask:0x8
    v_add_f32_dpp v54, v106, v107 row_shr:4 row_mask:0xf bank_mask:0x8
    v_add_f32_dpp v55, v110, v111 row_shr:4 row_mask:0xf bank_mask:0x8
    v_cvt_pk_bf16_f32 v53, v52, v53
    v_cvt_pk_bf16_f32 v55, v54, v55
    v_lshlrev_b32 v52, 16, v53
    v_lshlrev_b32 v54, 16, v55
    v_and_b32 v53, 0xffff0000, v53
    v_and_b32 v55, 0xffff0000, v55
    v_pk_mul_f32 v[52:53], v[52:53], s[10:11]
    v_pk_mul_f32 v[54:55], v[54:55], s[10:11]
    v_cvt_pk_bf16_f32 v53, v52, v53
    v_cvt_pk_bf16_f32 v55, v54, v55
    v_lshlrev_b32 v52, 16, v53
    v_lshlrev_b32 v54, 16, v55
    v_and_b32 v53, 0xffff0000, v53
    v_and_b32 v55, 0xffff0000, v55
    v_max3_f32 v7, v40, v41, v42
    v_max3_f32 v7, v7, v43, v44
    v_max3_f32 v7, v7, v45, v46
    v_max3_f32 v7, v7, v47, v48
    v_max3_f32 v7, v7, v49, v50
    v_max3_f32 v7, v7, v51, v52
    v_max3_f32 v7, v7, v53, v54
    v_max_f32 v7, v7, v55
    s_nop 1
    v_max_f32_dpp v7, v7, v7 row_ror:4 row_mask:0xf bank_mask:0xf
    s_nop 1
    v_max_f32_dpp v7, v7, v7 row_ror:8 row_mask:0xf bank_mask:0xf
    v_mov_b32 v5, v7
    s_nop 1
    v_permlane16_swap_b32 v7, v5
    v_max_f32 v7, v7, v5
    v_mov_b32 v5, v7
    s_nop 1
    v_permlane32_swap_b32 v7, v5
    v_max_f32 v7, v7, v5
    s_mov_b64 exec, 15
    ds_write_b32 v11, v7 offset:8192
    ds_write_b32 v11, v14 offset:8320
    s_mov_b64 exec, -1
    s_lshl_b32 s63, s3, 11
    v_lshl_add_u32 v4, v1, 2, s63
    s_lshl_b32 s63, s3, 9
    v_lshl_add_u32 v6, v1, 2, s63
    v_and_b32 v2, 15, v1
    v_lshrrev_b32 v5, 4, v1
    v_lshlrev_b32 v2, 4, v2
    v_lshl_add_u32 v2, v5, 2, v2
    s_waitcnt lgkmcnt(0)
    s_barrier
    ds_read_b128 v[80:83], v10 offset:8192
    ds_read_b32 v14, v13 offset:8320
    s_waitcnt lgkmcnt(0)
    v_max3_f32 v7, v80, v81, v82
    v_max_f32 v7, v7, v83
    v_mul_f32 v9, s62, v7
    v_fma_f32 v40, v40, s62, -v9
    v_fma_f32 v41, v41, s62, -v9
    v_fma_f32 v42, v42, s62, -v9
    v_fma_f32 v43, v43, s62, -v9
    v_fma_f32 v44, v44, s62, -v9
    v_fma_f32 v45, v45, s62, -v9
    v_fma_f32 v46, v46, s62, -v9
    v_fma_f32 v47, v47, s62, -v9
    v_fma_f32 v48, v48, s62, -v9
    v_fma_f32 v49, v49, s62, -v9
    v_fma_f32 v50, v50, s62, -v9
    v_fma_f32 v51, v51, s62, -v9
    v_fma_f32 v52, v52, s62, -v9
    v_fma_f32 v53, v53, s62, -v9
    v_fma_f32 v54, v54, s62, -v9
    v_fma_f32 v55, v55, s62, -v9
    v_exp_f32 v40, v40
    v_exp_f32 v41, v41
    v_exp_f32 v42, v42
    v_exp_f32 v43, v43
    v_exp_f32 v44, v44
    v_exp_f32 v45, v45
    v_exp_f32 v46, v46
    v_exp_f32 v47, v47
    v_exp_f32 v48, v48
    v_exp_f32 v49, v49
    v_exp_f32 v50, v50
    v_exp_f32 v51, v51
    v_exp_f32 v52, v52
    v_exp_f32 v53, v53
    v_exp_f32 v54, v54
    v_exp_f32 v55, v55
    v_add_f32 v8, v40, v41
    v_add_f32 v8, v8, v42
    v_add_f32 v8, v8, v43
    v_add_f32 v8, v8, v44
    v_add_f32 v8, v8, v45
    v_add_f32 v8, v8, v46
    v_add_f32 v8, v8, v47
    v_add_f32 v8, v8, v48
    v_add_f32 v8, v8, v49
    v_add_f32 v8, v8, v50
    v_add_f32 v8, v8, v51
    v_add_f32 v8, v8, v52
    v_add_f32 v8, v8, v53
    v_add_f32 v8, v8, v54
    v_add_f32 v8, v8, v55
    v_cvt_pk_bf16_f32 v40, v40, v41
    v_cvt_pk_bf16_f32 v41, v42, v43
    v_cvt_pk_bf16_f32 v44, v44, v45
    v_cvt_pk_bf16_f32 v45, v46, v47
    v_cvt_pk_bf16_f32 v48, v48, v49
    v_cvt_pk_bf16_f32 v49, v50, v51
    v_cvt_pk_bf16_f32 v52, v52, v53
    v_cvt_pk_bf16_f32 v53, v54, v55
    s_nop 1
    v_add_f32_dpp v8, v8, v8 row_ror:4 row_mask:0xf bank_mask:0xf
    s_nop 1
    v_add_f32_dpp v8, v8, v8 row_ror:8 row_mask:0xf bank_mask:0xf
    v_mov_b32 v5, v8
    s_nop 1
    v_permlane16_swap_b32 v8, v5
    v_add_f32 v8, v8, v5
    v_mov_b32 v5, v8
    s_nop 1
    v_permlane32_swap_b32 v8, v5
    v_add_f32 v8, v8, v5
    s_mov_b64 exec, 15
    ds_write_b32 v11, v8 offset:8256
    s_mov_b64 exec, -1
    v_readlane_b32 s49, v9, s3
    s_waitcnt vmcnt(16)
    buffer_load_dwordx4 v[160:163], v3, s[20:23], s45 offen offset:0 nt
    buffer_load_dwordx4 v[164:167], v3, s[20:23], s45 offen offset:1024 nt
    buffer_load_dwordx4 v[168:171], v3, s[20:23], s45 offen offset:2048 nt
    buffer_load_dwordx4 v[172:175], v3, s[20:23], s45 offen offset:3072 nt
    s_add_u32 s45, s45, 16384
    v_perm_b32 v80, v180, v176, s60
    v_perm_b32 v81, v188, v184, s60
    v_perm_b32 v84, v180, v176, s61
    v_perm_b32 v85, v188, v184, s61
    v_perm_b32 v88, v181, v177, s60
    v_perm_b32 v89, v189, v185, s60
    v_perm_b32 v92, v181, v177, s61
    v_perm_b32 v93, v189, v185, s61
    v_perm_b32 v96, v182, v178, s60
    v_perm_b32 v97, v190, v186, s60
    v_perm_b32 v100, v182, v178, s61
    v_perm_b32 v101, v190, v186, s61
    v_perm_b32 v104, v183, v179, s60
    v_perm_b32 v105, v191, v187, s60
    v_perm_b32 v108, v183, v179, s61
    v_perm_b32 v109, v191, v187, s61
    v_mov_b32_dpp v64, v40 quad_perm:[0,1,2,3] row_mask:0xf bank_mask:0x1
    v_mov_b32_dpp v65, v41 quad_perm:[0,1,2,3] row_mask:0xf bank_mask:0x1
    v_mov_b32_dpp v66, v40 row_shl:4 row_mask:0xf bank_mask:0x1
    v_mov_b32_dpp v67, v41 row_shl:4 row_mask:0xf bank_mask:0x1
    v_mov_b32_dpp v68, v40 row_shr:4 row_mask:0xf bank_mask:0x2
    v_mov_b32_dpp v69, v41 row_shr:4 row_mask:0xf bank_mask:0x2
    v_mov_b32_dpp v70, v40 quad_perm:[0,1,2,3] row_mask:0xf bank_mask:0x2
    v_mov_b32_dpp v71, v41 quad_perm:[0,1,2,3] row_mask:0xf bank_mask:0x2
    v_mov_b32_dpp v72, v40 row_shr:8 row_mask:0xf bank_mask:0x4
    v_mov_b32_dpp v73, v41 row_shr:8 row_mask:0xf bank_mask:0x4
    v_mov_b32_dpp v74, v40 row_shr:4 row_mask:0xf bank_mask:0x4
    v_mov_b32_dpp v75, v41 row_shr:4 row_mask:0xf bank_mask:0x4
    v_mov_b32_dpp v76, v40 row_shr:12 row_mask:0xf bank_mask:0x8
    v_mov_b32_dpp v77, v41 row_shr:12 row_mask:0xf bank_mask:0x8
    v_mov_b32_dpp v78, v40 row_shr:8 row_mask:0xf bank_mask:0x8
    v_mov_b32_dpp v79, v41 row_shr:8 row_mask:0xf bank_mask:0x8
    s_waitcnt lgkmcnt(0)
    s_barrier
    s_lshl_b32 s63, s3, 4
    v_mov_b32 v5, s63
    ds_read_b128 v[36:39], v5 offset:8256
    v_mov_b32 v18, s49
    s_waitcnt lgkmcnt(0)
    v_add_f32 v36, v36, v37
    v_add_f32 v38, v38, v39
    v_min_u32 v18, s43, v18
    v_add_f32 v19, v36, v38
    v_min_u32 v19, s43, v19
    s_waitcnt vmcnt(16)
    buffer_load_dwordx4 v[176:179], v3, s[20:23], s45 offen offset:0 nt
    buffer_load_dwordx4 v[180:183], v3, s[20:23], s45 offen offset:1024 nt
    buffer_load_dwordx4 v[184:187], v3, s[20:23], s45 offen offset:2048 nt
    buffer_load_dwordx4 v[188:191], v3, s[20:23], s45 offen offset:3072 nt
    s_add_u32 s45, s45, 16384
    v_perm_b32 v82, v196, v192, s60
    v_perm_b32 v83, v204, v200, s60
    v_perm_b32 v86, v196, v192, s61
    v_perm_b32 v87, v204, v200, s61
    v_perm_b32 v90, v197, v193, s60
    v_perm_b32 v91, v205, v201, s60
    v_perm_b32 v94, v197, v193, s61
    v_perm_b32 v95, v205, v201, s61
    v_perm_b32 v98, v198, v194, s60
    v_perm_b32 v99, v206, v202, s60
    v_perm_b32 v102, v198, v194, s61
    v_perm_b32 v103, v206, v202, s61
    v_perm_b32 v106, v199, v195, s60
    v_perm_b32 v107, v207, v203, s60
    v_perm_b32 v110, v199, v195, s61
    v_perm_b32 v111, v207, v203, s61
    v_mfma_f32_16x16x32_bf16 v[56:59], v[64:67], v[80:83], 0
    v_mfma_f32_16x16x32_bf16 v[60:63], v[64:67], v[84:87], 0
    v_mfma_f32_16x16x32_bf16 v[56:59], v[68:71], v[88:91], v[56:59]
    v_mfma_f32_16x16x32_bf16 v[60:63], v[68:71], v[92:95], v[60:63]
    v_mfma_f32_16x16x32_bf16 v[56:59], v[72:75], v[96:99], v[56:59]
    v_mfma_f32_16x16x32_bf16 v[60:63], v[72:75], v[100:103], v[60:63]
    v_mfma_f32_16x16x32_bf16 v[56:59], v[76:79], v[104:107], v[56:59]
    v_mfma_f32_16x16x32_bf16 v[60:63], v[76:79], v[108:111], v[60:63]
    v_readfirstlane_b32 s41, v14
    s_cmp_eq_u32 s37, 3
    s_cbranch_scc1 L_nopub
    s_cmp_lg_u32 s41, s40
    s_cbranch_scc1 L_nopub
    s_mov_b64 exec, 1
    buffer_store_dwordx2 v[18:19], v13, s[32:35], s48 offen offset:1536
    s_mov_b64 exec, -1
L_nopub:
    s_waitcnt vmcnt(16)
    buffer_load_dwordx4 v[192:195], v3, s[20:23], s45 offen offset:0 nt
    buffer_load_dwordx4 v[196:199], v3, s[20:23], s45 offen offset:1024 nt
    buffer_load_dwordx4 v[200:203], v3, s[20:23], s45 offen offset:2048 nt
    buffer_load_dwordx4 v[204:207], v3, s[20:23], s45 offen offset:3072 nt
    s_add_u32 s45, s45, 16384
    v_perm_b32 v80, v116, v112, s60
    v_perm_b32 v81, v124, v120, s60
    v_perm_b32 v84, v116, v112, s61
    v_perm_b32 v85, v124, v120, s61
    v_perm_b32 v88, v117, v113, s60
    v_perm_b32 v89, v125, v121, s60
    v_perm_b32 v92, v117, v113, s61
    v_perm_b32 v93, v125, v121, s61
    v_perm_b32 v96, v118, v114, s60
    v_perm_b32 v97, v126, v122, s60
    v_perm_b32 v100, v118, v114, s61
    v_perm_b32 v101, v126, v122, s61
    v_perm_b32 v104, v119, v115, s60
    v_perm_b32 v105, v127, v123, s60
    v_perm_b32 v108, v119, v115, s61
    v_perm_b32 v109, v127, v123, s61
    v_mov_b32_dpp v64, v40 row_shl:8 row_mask:0xf bank_mask:0x1
    v_mov_b32_dpp v65, v41 row_shl:8 row_mask:0xf bank_mask:0x1
    v_mov_b32_dpp v66, v40 row_shl:12 row_mask:0xf bank_mask:0x1
    v_mov_b32_dpp v67, v41 row_shl:12 row_mask:0xf bank_mask:0x1
    v_mov_b32_dpp v68, v40 row_shl:4 row_mask:0xf bank_mask:0x2
    v_mov_b32_dpp v69, v41 row_shl:4 row_mask:0xf bank_mask:0x2
    v_mov_b32_dpp v70, v40 row_shl:8 row_mask:0xf bank_mask:0x2
    v_mov_b32_dpp v71, v41 row_shl:8 row_mask:0xf bank_mask:0x2
    v_mov_b32_dpp v72, v40 quad_perm:[0,1,2,3] row_mask:0xf bank_mask:0x4
    v_mov_b32_dpp v73, v41 quad_perm:[0,1,2,3] row_mask:0xf bank_mask:0x4
    v_mov_b32_dpp v74, v40 row_shl:4 row_mask:0xf bank_mask:0x4
    v_mov_b32_dpp v75, v41 row_shl:4 row_mask:0xf bank_mask:0x4
    v_mov_b32_dpp v76, v40 row_shr:4 row_mask:0xf bank_mask:0x8
    v_mov_b32_dpp v77, v41 row_shr:4 row_mask:0xf bank_mask:0x8
    v_mov_b32_dpp v78, v40 quad_perm:[0,1,2,3] row_mask:0xf bank_mask:0x8
    v_mov_b32_dpp v79, v41 quad_perm:[0,1,2,3] row_mask:0xf bank_mask:0x8
    s_waitcnt vmcnt(16)
    buffer_load_dwordx4 v[112:115], v3, s[20:23], s45 offen offset:0 nt
    buffer_load_dwordx4 v[116:119], v3, s[20:23], s45 offen offset:1024 nt
    buffer_load_dwordx4 v[120:123], v3, s[20:23], s45 offen offset:2048 nt
    buffer_load_dwordx4 v[124:127], v3, s[20:23], s45 offen offset:3072 nt
    s_add_u32 s45, s45, 16384
    v_perm_b32 v82, v132, v128, s60
    v_perm_b32 v83, v140, v136, s60
    v_perm_b32 v86, v132, v128, s61
    v_perm_b32 v87, v140, v136, s61
    v_perm_b32 v90, v133, v129, s60
    v_perm_b32 v91, v141, v137, s60
    v_perm_b32 v94, v133, v129, s61
    v_perm_b32 v95, v141, v137, s61
    v_perm_b32 v98, v134, v130, s60
    v_perm_b32 v99, v142, v138, s60
    v_perm_b32 v102, v134, v130, s61
    v_perm_b32 v103, v142, v138, s61
    v_perm_b32 v106, v135, v131, s60
    v_perm_b32 v107, v143, v139, s60
    v_perm_b32 v110, v135, v131, s61
    v_perm_b32 v111, v143, v139, s61
    v_mfma_f32_16x16x32_bf16 v[56:59], v[64:67], v[80:83], v[56:59]
    v_mfma_f32_16x16x32_bf16 v[60:63], v[64:67], v[84:87], v[60:63]
    v_mfma_f32_16x16x32_bf16 v[56:59], v[68:71], v[88:91], v[56:59]
    v_mfma_f32_16x16x32_bf16 v[60:63], v[68:71], v[92:95], v[60:63]
    v_mfma_f32_16x16x32_bf16 v[56:59], v[72:75], v[96:99], v[56:59]
    v_mfma_f32_16x16x32_bf16 v[60:63], v[72:75], v[100:103], v[60:63]
    v_mfma_f32_16x16x32_bf16 v[56:59], v[76:79], v[104:107], v[56:59]
    v_mfma_f32_16x16x32_bf16 v[60:63], v[76:79], v[108:111], v[60:63]
    s_waitcnt vmcnt(16)
    buffer_load_dwordx4 v[128:131], v3, s[20:23], s45 offen offset:0 nt
    buffer_load_dwordx4 v[132:135], v3, s[20:23], s45 offen offset:1024 nt
    buffer_load_dwordx4 v[136:139], v3, s[20:23], s45 offen offset:2048 nt
    buffer_load_dwordx4 v[140:143], v3, s[20:23], s45 offen offset:3072 nt
    s_add_u32 s45, s45, 16384
    v_perm_b32 v80, v148, v144, s60
    v_perm_b32 v81, v156, v152, s60
    v_perm_b32 v84, v148, v144, s61
    v_perm_b32 v85, v156, v152, s61
    v_perm_b32 v88, v149, v145, s60
    v_perm_b32 v89, v157, v153, s60
    v_perm_b32 v92, v149, v145, s61
    v_perm_b32 v93, v157, v153, s61
    v_perm_b32 v96, v150, v146, s60
    v_perm_b32 v97, v158, v154, s60
    v_perm_b32 v100, v150, v146, s61
    v_perm_b32 v101, v158, v154, s61
    v_perm_b32 v104, v151, v147, s60
    v_perm_b32 v105, v159, v155, s60
    v_perm_b32 v108, v151, v147, s61
    v_perm_b32 v109, v159, v155, s61
    v_mov_b32_dpp v64, v44 quad_perm:[0,1,2,3] row_mask:0xf bank_mask:0x1
    v_mov_b32_dpp v65, v45 quad_perm:[0,1,2,3] row_mask:0xf bank_mask:0x1
    v_mov_b32_dpp v66, v44 row_shl:4 row_mask:0xf bank_mask:0x1
    v_mov_b32_dpp v67, v45 row_shl:4 row_mask:0xf bank_mask:0x1
    v_mov_b32_dpp v68, v44 row_shr:4 row_mask:0xf bank_mask:0x2
    v_mov_b32_dpp v69, v45 row_shr:4 row_mask:0xf bank_mask:0x2
    v_mov_b32_dpp v70, v44 quad_perm:[0,1,2,3] row_mask:0xf bank_mask:0x2
    v_mov_b32_dpp v71, v45 quad_perm:[0,1,2,3] row_mask:0xf bank_mask:0x2
    v_mov_b32_dpp v72, v44 row_shr:8 row_mask:0xf bank_mask:0x4
    v_mov_b32_dpp v73, v45 row_shr:8 row_mask:0xf bank_mask:0x4
    v_mov_b32_dpp v74, v44 row_shr:4 row_mask:0xf bank_mask:0x4
    v_mov_b32_dpp v75, v45 row_shr:4 row_mask:0xf bank_mask:0x4
    v_mov_b32_dpp v76, v44 row_shr:12 row_mask:0xf bank_mask:0x8
    v_mov_b32_dpp v77, v45 row_shr:12 row_mask:0xf bank_mask:0x8
    v_mov_b32_dpp v78, v44 row_shr:8 row_mask:0xf bank_mask:0x8
    v_mov_b32_dpp v79, v45 row_shr:8 row_mask:0xf bank_mask:0x8
    s_waitcnt vmcnt(16)
    buffer_load_dwordx4 v[144:147], v3, s[20:23], s45 offen offset:0 nt
    buffer_load_dwordx4 v[148:151], v3, s[20:23], s45 offen offset:1024 nt
    buffer_load_dwordx4 v[152:155], v3, s[20:23], s45 offen offset:2048 nt
    buffer_load_dwordx4 v[156:159], v3, s[20:23], s45 offen offset:3072 nt
    s_add_u32 s45, s45, 16384
    v_perm_b32 v82, v164, v160, s60
    v_perm_b32 v83, v172, v168, s60
    v_perm_b32 v86, v164, v160, s61
    v_perm_b32 v87, v172, v168, s61
    v_perm_b32 v90, v165, v161, s60
    v_perm_b32 v91, v173, v169, s60
    v_perm_b32 v94, v165, v161, s61
    v_perm_b32 v95, v173, v169, s61
    v_perm_b32 v98, v166, v162, s60
    v_perm_b32 v99, v174, v170, s60
    v_perm_b32 v102, v166, v162, s61
    v_perm_b32 v103, v174, v170, s61
    v_perm_b32 v106, v167, v163, s60
    v_perm_b32 v107, v175, v171, s60
    v_perm_b32 v110, v167, v163, s61
    v_perm_b32 v111, v175, v171, s61
    v_mfma_f32_16x16x32_bf16 v[56:59], v[64:67], v[80:83], v[56:59]
    v_mfma_f32_16x16x32_bf16 v[60:63], v[64:67], v[84:87], v[60:63]
    v_mfma_f32_16x16x32_bf16 v[56:59], v[68:71], v[88:91], v[56:59]
    v_mfma_f32_16x16x32_bf16 v[60:63], v[68:71], v[92:95], v[60:63]
    v_mfma_f32_16x16x32_bf16 v[56:59], v[72:75], v[96:99], v[56:59]
    v_mfma_f32_16x16x32_bf16 v[60:63], v[72:75], v[100:103], v[60:63]
    v_mfma_f32_16x16x32_bf16 v[56:59], v[76:79], v[104:107], v[56:59]
    v_mfma_f32_16x16x32_bf16 v[60:63], v[76:79], v[108:111], v[60:63]
    s_waitcnt vmcnt(16)
    buffer_load_dwordx4 v[160:163], v3, s[20:23], s45 offen offset:0 nt
    buffer_load_dwordx4 v[164:167], v3, s[20:23], s45 offen offset:1024 nt
    buffer_load_dwordx4 v[168:171], v3, s[20:23], s45 offen offset:2048 nt
    buffer_load_dwordx4 v[172:175], v3, s[20:23], s45 offen offset:3072 nt
    s_add_u32 s45, s45, 16384
    v_perm_b32 v80, v180, v176, s60
    v_perm_b32 v81, v188, v184, s60
    v_perm_b32 v84, v180, v176, s61
    v_perm_b32 v85, v188, v184, s61
    v_perm_b32 v88, v181, v177, s60
    v_perm_b32 v89, v189, v185, s60
    v_perm_b32 v92, v181, v177, s61
    v_perm_b32 v93, v189, v185, s61
    v_perm_b32 v96, v182, v178, s60
    v_perm_b32 v97, v190, v186, s60
    v_perm_b32 v100, v182, v178, s61
    v_perm_b32 v101, v190, v186, s61
    v_perm_b32 v104, v183, v179, s60
    v_perm_b32 v105, v191, v187, s60
    v_perm_b32 v108, v183, v179, s61
    v_perm_b32 v109, v191, v187, s61
    v_mov_b32_dpp v64, v44 row_shl:8 row_mask:0xf bank_mask:0x1
    v_mov_b32_dpp v65, v45 row_shl:8 row_mask:0xf bank_mask:0x1
    v_mov_b32_dpp v66, v44 row_shl:12 row_mask:0xf bank_mask:0x1
    v_mov_b32_dpp v67, v45 row_shl:12 row_mask:0xf bank_mask:0x1
    v_mov_b32_dpp v68, v44 row_shl:4 row_mask:0xf bank_mask:0x2
    v_mov_b32_dpp v69, v45 row_shl:4 row_mask:0xf bank_mask:0x2
    v_mov_b32_dpp v70, v44 row_shl:8 row_mask:0xf bank_mask:0x2
    v_mov_b32_dpp v71, v45 row_shl:8 row_mask:0xf bank_mask:0x2
    v_mov_b32_dpp v72, v44 quad_perm:[0,1,2,3] row_mask:0xf bank_mask:0x4
    v_mov_b32_dpp v73, v45 quad_perm:[0,1,2,3] row_mask:0xf bank_mask:0x4
    v_mov_b32_dpp v74, v44 row_shl:4 row_mask:0xf bank_mask:0x4
    v_mov_b32_dpp v75, v45 row_shl:4 row_mask:0xf bank_mask:0x4
    v_mov_b32_dpp v76, v44 row_shr:4 row_mask:0xf bank_mask:0x8
    v_mov_b32_dpp v77, v45 row_shr:4 row_mask:0xf bank_mask:0x8
    v_mov_b32_dpp v78, v44 quad_perm:[0,1,2,3] row_mask:0xf bank_mask:0x8
    v_mov_b32_dpp v79, v45 quad_perm:[0,1,2,3] row_mask:0xf bank_mask:0x8
    s_waitcnt vmcnt(16)
    buffer_load_dwordx4 v[176:179], v3, s[20:23], s45 offen offset:0 nt
    buffer_load_dwordx4 v[180:183], v3, s[20:23], s45 offen offset:1024 nt
    buffer_load_dwordx4 v[184:187], v3, s[20:23], s45 offen offset:2048 nt
    buffer_load_dwordx4 v[188:191], v3, s[20:23], s45 offen offset:3072 nt
    s_add_u32 s45, s45, 16384
    v_perm_b32 v82, v196, v192, s60
    v_perm_b32 v83, v204, v200, s60
    v_perm_b32 v86, v196, v192, s61
    v_perm_b32 v87, v204, v200, s61
    v_perm_b32 v90, v197, v193, s60
    v_perm_b32 v91, v205, v201, s60
    v_perm_b32 v94, v197, v193, s61
    v_perm_b32 v95, v205, v201, s61
    v_perm_b32 v98, v198, v194, s60
    v_perm_b32 v99, v206, v202, s60
    v_perm_b32 v102, v198, v194, s61
    v_perm_b32 v103, v206, v202, s61
    v_perm_b32 v106, v199, v195, s60
    v_perm_b32 v107, v207, v203, s60
    v_perm_b32 v110, v199, v195, s61
    v_perm_b32 v111, v207, v203, s61
    v_mfma_f32_16x16x32_bf16 v[56:59], v[64:67], v[80:83], v[56:59]
    v_mfma_f32_16x16x32_bf16 v[60:63], v[64:67], v[84:87], v[60:63]
    v_mfma_f32_16x16x32_bf16 v[56:59], v[68:71], v[88:91], v[56:59]
    v_mfma_f32_16x16x32_bf16 v[60:63], v[68:71], v[92:95], v[60:63]
    v_mfma_f32_16x16x32_bf16 v[56:59], v[72:75], v[96:99], v[56:59]
    v_mfma_f32_16x16x32_bf16 v[60:63], v[72:75], v[100:103], v[60:63]
    v_mfma_f32_16x16x32_bf16 v[56:59], v[76:79], v[104:107], v[56:59]
    v_mfma_f32_16x16x32_bf16 v[60:63], v[76:79], v[108:111], v[60:63]
    s_waitcnt vmcnt(16)
    buffer_load_dwordx4 v[192:195], v3, s[20:23], s45 offen offset:0 nt
    buffer_load_dwordx4 v[196:199], v3, s[20:23], s45 offen offset:1024 nt
    buffer_load_dwordx4 v[200:203], v3, s[20:23], s45 offen offset:2048 nt
    buffer_load_dwordx4 v[204:207], v3, s[20:23], s45 offen offset:3072 nt
    s_add_u32 s45, s45, 16384
    v_perm_b32 v80, v116, v112, s60
    v_perm_b32 v81, v124, v120, s60
    v_perm_b32 v84, v116, v112, s61
    v_perm_b32 v85, v124, v120, s61
    v_perm_b32 v88, v117, v113, s60
    v_perm_b32 v89, v125, v121, s60
    v_perm_b32 v92, v117, v113, s61
    v_perm_b32 v93, v125, v121, s61
    v_perm_b32 v96, v118, v114, s60
    v_perm_b32 v97, v126, v122, s60
    v_perm_b32 v100, v118, v114, s61
    v_perm_b32 v101, v126, v122, s61
    v_perm_b32 v104, v119, v115, s60
    v_perm_b32 v105, v127, v123, s60
    v_perm_b32 v108, v119, v115, s61
    v_perm_b32 v109, v127, v123, s61
    v_mov_b32_dpp v64, v48 quad_perm:[0,1,2,3] row_mask:0xf bank_mask:0x1
    v_mov_b32_dpp v65, v49 quad_perm:[0,1,2,3] row_mask:0xf bank_mask:0x1
    v_mov_b32_dpp v66, v48 row_shl:4 row_mask:0xf bank_mask:0x1
    v_mov_b32_dpp v67, v49 row_shl:4 row_mask:0xf bank_mask:0x1
    v_mov_b32_dpp v68, v48 row_shr:4 row_mask:0xf bank_mask:0x2
    v_mov_b32_dpp v69, v49 row_shr:4 row_mask:0xf bank_mask:0x2
    v_mov_b32_dpp v70, v48 quad_perm:[0,1,2,3] row_mask:0xf bank_mask:0x2
    v_mov_b32_dpp v71, v49 quad_perm:[0,1,2,3] row_mask:0xf bank_mask:0x2
    v_mov_b32_dpp v72, v48 row_shr:8 row_mask:0xf bank_mask:0x4
    v_mov_b32_dpp v73, v49 row_shr:8 row_mask:0xf bank_mask:0x4
    v_mov_b32_dpp v74, v48 row_shr:4 row_mask:0xf bank_mask:0x4
    v_mov_b32_dpp v75, v49 row_shr:4 row_mask:0xf bank_mask:0x4
    v_mov_b32_dpp v76, v48 row_shr:12 row_mask:0xf bank_mask:0x8
    v_mov_b32_dpp v77, v49 row_shr:12 row_mask:0xf bank_mask:0x8
    v_mov_b32_dpp v78, v48 row_shr:8 row_mask:0xf bank_mask:0x8
    v_mov_b32_dpp v79, v49 row_shr:8 row_mask:0xf bank_mask:0x8
    s_waitcnt vmcnt(16)
    s_cmp_lg_u32 s37, 3
    s_cbranch_scc1 L_mlp
    buffer_load_dwordx2 v[24:25], v13, s[32:35], s53 offen offset:1536 sc1
    buffer_load_dwordx2 v[26:27], v13, s[32:35], s54 offen offset:1544 sc1
    buffer_load_dwordx2 v[28:29], v13, s[32:35], s55 offen offset:1552 sc1
    s_branch L_mlq
L_mlp:
    buffer_load_dwordx2 v[22:23], v15, s[32:35], s47 offen sc1
L_mlq:
    buffer_load_dwordx4 v[112:115], v3, s[20:23], s45 offen offset:0 nt
    buffer_load_dwordx4 v[116:119], v3, s[20:23], s45 offen offset:1024 nt
    buffer_load_dwordx4 v[120:123], v3, s[20:23], s45 offen offset:2048 nt
    buffer_load_dwordx4 v[124:127], v3, s[20:23], s45 offen offset:3072 nt
    s_add_u32 s45, s45, 16384
    v_perm_b32 v82, v132, v128, s60
    v_perm_b32 v83, v140, v136, s60
    v_perm_b32 v86, v132, v128, s61
    v_perm_b32 v87, v140, v136, s61
    v_perm_b32 v90, v133, v129, s60
    v_perm_b32 v91, v141, v137, s60
    v_perm_b32 v94, v133, v129, s61
    v_perm_b32 v95, v141, v137, s61
    v_perm_b32 v98, v134, v130, s60
    v_perm_b32 v99, v142, v138, s60
    v_perm_b32 v102, v134, v130, s61
    v_perm_b32 v103, v142, v138, s61
    v_perm_b32 v106, v135, v131, s60
    v_perm_b32 v107, v143, v139, s60
    v_perm_b32 v110, v135, v131, s61
    v_perm_b32 v111, v143, v139, s61
    v_mfma_f32_16x16x32_bf16 v[56:59], v[64:67], v[80:83], v[56:59]
    v_mfma_f32_16x16x32_bf16 v[60:63], v[64:67], v[84:87], v[60:63]
    v_mfma_f32_16x16x32_bf16 v[56:59], v[68:71], v[88:91], v[56:59]
    v_mfma_f32_16x16x32_bf16 v[60:63], v[68:71], v[92:95], v[60:63]
    v_mfma_f32_16x16x32_bf16 v[56:59], v[72:75], v[96:99], v[56:59]
    v_mfma_f32_16x16x32_bf16 v[60:63], v[72:75], v[100:103], v[60:63]
    v_mfma_f32_16x16x32_bf16 v[56:59], v[76:79], v[104:107], v[56:59]
    v_mfma_f32_16x16x32_bf16 v[60:63], v[76:79], v[108:111], v[60:63]
    s_waitcnt vmcnt(17)
    buffer_load_dwordx4 v[128:131], v3, s[20:23], s45 offen offset:0 nt
    buffer_load_dwordx4 v[132:135], v3, s[20:23], s45 offen offset:1024 nt
    buffer_load_dwordx4 v[136:139], v3, s[20:23], s45 offen offset:2048 nt
    buffer_load_dwordx4 v[140:143], v3, s[20:23], s45 offen offset:3072 nt
    v_perm_b32 v80, v148, v144, s60
    v_perm_b32 v81, v156, v152, s60
    v_perm_b32 v84, v148, v144, s61
    v_perm_b32 v85, v156, v152, s61
    v_perm_b32 v88, v149, v145, s60
    v_perm_b32 v89, v157, v153, s60
    v_perm_b32 v92, v149, v145, s61
    v_perm_b32 v93, v157, v153, s61
    v_perm_b32 v96, v150, v146, s60
    v_perm_b32 v97, v158, v154, s60
    v_perm_b32 v100, v150, v146, s61
    v_perm_b32 v101, v158, v154, s61
    v_perm_b32 v104, v151, v147, s60
    v_perm_b32 v105, v159, v155, s60
    v_perm_b32 v108, v151, v147, s61
    v_perm_b32 v109, v159, v155, s61
    v_mov_b32_dpp v64, v48 row_shl:8 row_mask:0xf bank_mask:0x1
    v_mov_b32_dpp v65, v49 row_shl:8 row_mask:0xf bank_mask:0x1
    v_mov_b32_dpp v66, v48 row_shl:12 row_mask:0xf bank_mask:0x1
    v_mov_b32_dpp v67, v49 row_shl:12 row_mask:0xf bank_mask:0x1
    v_mov_b32_dpp v68, v48 row_shl:4 row_mask:0xf bank_mask:0x2
    v_mov_b32_dpp v69, v49 row_shl:4 row_mask:0xf bank_mask:0x2
    v_mov_b32_dpp v70, v48 row_shl:8 row_mask:0xf bank_mask:0x2
    v_mov_b32_dpp v71, v49 row_shl:8 row_mask:0xf bank_mask:0x2
    v_mov_b32_dpp v72, v48 quad_perm:[0,1,2,3] row_mask:0xf bank_mask:0x4
    v_mov_b32_dpp v73, v49 quad_perm:[0,1,2,3] row_mask:0xf bank_mask:0x4
    v_mov_b32_dpp v74, v48 row_shl:4 row_mask:0xf bank_mask:0x4
    v_mov_b32_dpp v75, v49 row_shl:4 row_mask:0xf bank_mask:0x4
    v_mov_b32_dpp v76, v48 row_shr:4 row_mask:0xf bank_mask:0x8
    v_mov_b32_dpp v77, v49 row_shr:4 row_mask:0xf bank_mask:0x8
    v_mov_b32_dpp v78, v48 quad_perm:[0,1,2,3] row_mask:0xf bank_mask:0x8
    v_mov_b32_dpp v79, v49 quad_perm:[0,1,2,3] row_mask:0xf bank_mask:0x8
    s_waitcnt vmcnt(17)
    v_perm_b32 v82, v164, v160, s60
    v_perm_b32 v83, v172, v168, s60
    v_perm_b32 v86, v164, v160, s61
    v_perm_b32 v87, v172, v168, s61
    v_perm_b32 v90, v165, v161, s60
    v_perm_b32 v91, v173, v169, s60
    v_perm_b32 v94, v165, v161, s61
    v_perm_b32 v95, v173, v169, s61
    v_perm_b32 v98, v166, v162, s60
    v_perm_b32 v99, v174, v170, s60
    v_perm_b32 v102, v166, v162, s61
    v_perm_b32 v103, v174, v170, s61
    v_perm_b32 v106, v167, v163, s60
    v_perm_b32 v107, v175, v171, s60
    v_perm_b32 v110, v167, v163, s61
    v_perm_b32 v111, v175, v171, s61
    v_mfma_f32_16x16x32_bf16 v[56:59], v[64:67], v[80:83], v[56:59]
    v_mfma_f32_16x16x32_bf16 v[60:63], v[64:67], v[84:87], v[60:63]
    v_mfma_f32_16x16x32_bf16 v[56:59], v[68:71], v[88:91], v[56:59]
    v_mfma_f32_16x16x32_bf16 v[60:63], v[68:71], v[92:95], v[60:63]
    v_mfma_f32_16x16x32_bf16 v[56:59], v[72:75], v[96:99], v[56:59]
    v_mfma_f32_16x16x32_bf16 v[60:63], v[72:75], v[100:103], v[60:63]
    v_mfma_f32_16x16x32_bf16 v[56:59], v[76:79], v[104:107], v[56:59]
    v_mfma_f32_16x16x32_bf16 v[60:63], v[76:79], v[108:111], v[60:63]
    s_waitcnt vmcnt(13)
    v_perm_b32 v80, v180, v176, s60
    v_perm_b32 v81, v188, v184, s60
    v_perm_b32 v84, v180, v176, s61
    v_perm_b32 v85, v188, v184, s61
    v_perm_b32 v88, v181, v177, s60
    v_perm_b32 v89, v189, v185, s60
    v_perm_b32 v92, v181, v177, s61
    v_perm_b32 v93, v189, v185, s61
    v_perm_b32 v96, v182, v178, s60
    v_perm_b32 v97, v190, v186, s60
    v_perm_b32 v100, v182, v178, s61
    v_perm_b32 v101, v190, v186, s61
    v_perm_b32 v104, v183, v179, s60
    v_perm_b32 v105, v191, v187, s60
    v_perm_b32 v108, v183, v179, s61
    v_perm_b32 v109, v191, v187, s61
    v_mov_b32_dpp v64, v52 quad_perm:[0,1,2,3] row_mask:0xf bank_mask:0x1
    v_mov_b32_dpp v65, v53 quad_perm:[0,1,2,3] row_mask:0xf bank_mask:0x1
    v_mov_b32_dpp v66, v52 row_shl:4 row_mask:0xf bank_mask:0x1
    v_mov_b32_dpp v67, v53 row_shl:4 row_mask:0xf bank_mask:0x1
    v_mov_b32_dpp v68, v52 row_shr:4 row_mask:0xf bank_mask:0x2
    v_mov_b32_dpp v69, v53 row_shr:4 row_mask:0xf bank_mask:0x2
    v_mov_b32_dpp v70, v52 quad_perm:[0,1,2,3] row_mask:0xf bank_mask:0x2
    v_mov_b32_dpp v71, v53 quad_perm:[0,1,2,3] row_mask:0xf bank_mask:0x2
    v_mov_b32_dpp v72, v52 row_shr:8 row_mask:0xf bank_mask:0x4
    v_mov_b32_dpp v73, v53 row_shr:8 row_mask:0xf bank_mask:0x4
    v_mov_b32_dpp v74, v52 row_shr:4 row_mask:0xf bank_mask:0x4
    v_mov_b32_dpp v75, v53 row_shr:4 row_mask:0xf bank_mask:0x4
    v_mov_b32_dpp v76, v52 row_shr:12 row_mask:0xf bank_mask:0x8
    v_mov_b32_dpp v77, v53 row_shr:12 row_mask:0xf bank_mask:0x8
    v_mov_b32_dpp v78, v52 row_shr:8 row_mask:0xf bank_mask:0x8
    v_mov_b32_dpp v79, v53 row_shr:8 row_mask:0xf bank_mask:0x8
    s_waitcnt vmcnt(9)
    v_perm_b32 v82, v196, v192, s60
    v_perm_b32 v83, v204, v200, s60
    v_perm_b32 v86, v196, v192, s61
    v_perm_b32 v87, v204, v200, s61
    v_perm_b32 v90, v197, v193, s60
    v_perm_b32 v91, v205, v201, s60
    v_perm_b32 v94, v197, v193, s61
    v_perm_b32 v95, v205, v201, s61
    v_perm_b32 v98, v198, v194, s60
    v_perm_b32 v99, v206, v202, s60
    v_perm_b32 v102, v198, v194, s61
    v_perm_b32 v103, v206, v202, s61
    v_perm_b32 v106, v199, v195, s60
    v_perm_b32 v107, v207, v203, s60
    v_perm_b32 v110, v199, v195, s61
    v_perm_b32 v111, v207, v203, s61
    v_mfma_f32_16x16x32_bf16 v[56:59], v[64:67], v[80:83], v[56:59]
    v_mfma_f32_16x16x32_bf16 v[60:63], v[64:67], v[84:87], v[60:63]
    v_mfma_f32_16x16x32_bf16 v[56:59], v[68:71], v[88:91], v[56:59]
    v_mfma_f32_16x16x32_bf16 v[60:63], v[68:71], v[92:95], v[60:63]
    v_mfma_f32_16x16x32_bf16 v[56:59], v[72:75], v[96:99], v[56:59]
    v_mfma_f32_16x16x32_bf16 v[60:63], v[72:75], v[100:103], v[60:63]
    v_mfma_f32_16x16x32_bf16 v[56:59], v[76:79], v[104:107], v[56:59]
    v_mfma_f32_16x16x32_bf16 v[60:63], v[76:79], v[108:111], v[60:63]
    s_waitcnt vmcnt(4)
    v_perm_b32 v80, v116, v112, s60
    v_perm_b32 v81, v124, v120, s60
    v_perm_b32 v84, v116, v112, s61
    v_perm_b32 v85, v124, v120, s61
    v_perm_b32 v88, v117, v113, s60
    v_perm_b32 v89, v125, v121, s60
    v_perm_b32 v92, v117, v113, s61
    v_perm_b32 v93, v125, v121, s61
    v_perm_b32 v96, v118, v114, s60
    v_perm_b32 v97, v126, v122, s60
    v_perm_b32 v100, v118, v114, s61
    v_perm_b32 v101, v126, v122, s61
    v_perm_b32 v104, v119, v115, s60
    v_perm_b32 v105, v127, v123, s60
    v_perm_b32 v108, v119, v115, s61
    v_perm_b32 v109, v127, v123, s61
    v_mov_b32_dpp v64, v52 row_shl:8 row_mask:0xf bank_mask:0x1
    v_mov_b32_dpp v65, v53 row_shl:8 row_mask:0xf bank_mask:0x1
    v_mov_b32_dpp v66, v52 row_shl:12 row_mask:0xf bank_mask:0x1
    v_mov_b32_dpp v67, v53 row_shl:12 row_mask:0xf bank_mask:0x1
    v_mov_b32_dpp v68, v52 row_shl:4 row_mask:0xf bank_mask:0x2
    v_mov_b32_dpp v69, v53 row_shl:4 row_mask:0xf bank_mask:0x2
    v_mov_b32_dpp v70, v52 row_shl:8 row_mask:0xf bank_mask:0x2
    v_mov_b32_dpp v71, v53 row_shl:8 row_mask:0xf bank_mask:0x2
    v_mov_b32_dpp v72, v52 quad_perm:[0,1,2,3] row_mask:0xf bank_mask:0x4
    v_mov_b32_dpp v73, v53 quad_perm:[0,1,2,3] row_mask:0xf bank_mask:0x4
    v_mov_b32_dpp v74, v52 row_shl:4 row_mask:0xf bank_mask:0x4
    v_mov_b32_dpp v75, v53 row_shl:4 row_mask:0xf bank_mask:0x4
    v_mov_b32_dpp v76, v52 row_shr:4 row_mask:0xf bank_mask:0x8
    v_mov_b32_dpp v77, v53 row_shr:4 row_mask:0xf bank_mask:0x8
    v_mov_b32_dpp v78, v52 quad_perm:[0,1,2,3] row_mask:0xf bank_mask:0x8
    v_mov_b32_dpp v79, v53 quad_perm:[0,1,2,3] row_mask:0xf bank_mask:0x8
    s_cmp_lg_u32 s37, 3
    s_cbranch_scc1 L_prod
    s_mov_b32 s59, 0x100000
    v_max3_u32 v14, v24, v25, v26
    v_max3_u32 v14, v14, v27, v28
    v_max_u32 v14, v14, v29
    v_cmp_eq_u32 vcc, -1, v14
    s_mov_b32 s51, 0
    s_cbranch_vccz L_mlok
    s_mov_b32 s51, 1
L_mlok:
    v_max3_f32 v7, v18, v24, v26
    v_max_f32 v7, v7, v28
    v_sub_f32 v36, v18, v7
    v_sub_f32 v37, v24, v7
    v_sub_f32 v38, v26, v7
    v_sub_f32 v39, v28, v7
    v_exp_f32 v36, v36
    v_exp_f32 v37, v37
    v_exp_f32 v38, v38
    v_exp_f32 v39, v39
    s_nop 0
    v_mul_f32 v8, v36, v19
    v_fmac_f32 v8, v37, v25
    v_fmac_f32 v8, v38, v27
    v_fmac_f32 v8, v39, v29
    v_rcp_f32 v8, v8
    s_nop 0
    v_mul_f32 v36, v36, v8
    v_mul_f32 v37, v37, v8
    v_mul_f32 v38, v38, v8
    v_mul_f32 v39, v39, v8
    s_waitcnt vmcnt(2)
    v_perm_b32 v82, v132, v128, s60
    v_perm_b32 v86, v132, v128, s61
    v_perm_b32 v90, v133, v129, s60
    v_perm_b32 v94, v133, v129, s61
    v_perm_b32 v98, v134, v130, s60
    v_perm_b32 v102, v134, v130, s61
    v_perm_b32 v106, v135, v131, s60
    v_perm_b32 v110, v135, v131, s61
    s_waitcnt vmcnt(0)
    v_perm_b32 v83, v140, v136, s60
    v_perm_b32 v87, v140, v136, s61
    v_perm_b32 v91, v141, v137, s60
    v_mfma_f32_16x16x32_bf16 v[56:59], v[64:67], v[80:83], v[56:59]
    v_perm_b32 v95, v141, v137, s61
    v_mfma_f32_16x16x32_bf16 v[60:63], v[64:67], v[84:87], v[60:63]
    v_perm_b32 v99, v142, v138, s60
    v_mfma_f32_16x16x32_bf16 v[56:59], v[68:71], v[88:91], v[56:59]
    v_perm_b32 v103, v142, v138, s61
    v_mfma_f32_16x16x32_bf16 v[60:63], v[68:71], v[92:95], v[60:63]
    v_perm_b32 v107, v143, v139, s60
    v_mfma_f32_16x16x32_bf16 v[56:59], v[72:75], v[96:99], v[56:59]
    v_perm_b32 v111, v143, v139, s61
    v_mfma_f32_16x16x32_bf16 v[60:63], v[72:75], v[100:103], v[60:63]
    v_mfma_f32_16x16x32_bf16 v[56:59], v[76:79], v[104:107], v[56:59]
    v_mfma_f32_16x16x32_bf16 v[60:63], v[76:79], v[108:111], v[60:63]
    buffer_load_dwordx2 v[30:31], v15, s[32:35], s53 offen offset:0 sc1
    buffer_load_dwordx2 v[32:33], v15, s[32:35], s54 offen offset:512 sc1
    buffer_load_dwordx2 v[34:35], v15, s[32:35], s55 offen offset:1024 sc1
    s_nop 4
    ds_write2st64_b32 v4, v56, v60 offset0:0 offset1:1
    ds_write2st64_b32 v4, v57, v61 offset0:2 offset1:3
    ds_write2st64_b32 v4, v58, v62 offset0:4 offset1:5
    ds_write2st64_b32 v4, v59, v63 offset0:6 offset1:7
    s_waitcnt lgkmcnt(0)
    s_barrier
    ds_read2st64_b32 v[80:81], v6 offset0:0 offset1:1
    ds_read2st64_b32 v[82:83], v6 offset0:8 offset1:9
    ds_read2st64_b32 v[84:85], v6 offset0:16 offset1:17
    ds_read2st64_b32 v[86:87], v6 offset0:24 offset1:25
    s_waitcnt lgkmcnt(2)
    v_pk_add_f32 v[80:81], v[80:81], v[82:83]
    s_waitcnt lgkmcnt(0)
    v_pk_add_f32 v[84:85], v[84:85], v[86:87]
    v_pk_add_f32 v[16:17], v[80:81], v[84:85]
    s_cmp_eq_u32 s51, 0
    s_cbranch_scc1 L_scale
L_pollA:
    s_sub_u32 s59, s59, 1
    s_cbranch_scc1 L_haveA
    s_and_b32 s41, s59, 7
    s_cbranch_scc1 L_reA
    global_load_ushort v14, v12, s[12:13] offset:128 sc1
    s_waitcnt vmcnt(0)
    v_readfirstlane_b32 s41, v14
    s_bitcmp1_b32 s41, 0
    s_cselect_b32 s42, 0x100000, 0
    s_or_b32 s53, s53, s42
    s_bitcmp1_b32 s41, 1
    s_cselect_b32 s42, 0x100000, 0
    s_or_b32 s54, s54, s42
    s_bitcmp1_b32 s41, 2
    s_cselect_b32 s42, 0x100000, 0
    s_or_b32 s55, s55, s42
L_reA:
    buffer_load_dwordx2 v[24:25], v13, s[32:35], s53 offen offset:1536 sc1
    buffer_load_dwordx2 v[26:27], v13, s[32:35], s54 offen offset:1544 sc1
    buffer_load_dwordx2 v[28:29], v13, s[32:35], s55 offen offset:1552 sc1
    s_waitcnt vmcnt(0)
    v_max3_u32 v14, v24, v25, v26
    v_max3_u32 v14, v14, v27, v28
    v_max_u32 v14, v14, v29
    v_cmp_eq_u32 vcc, -1, v14
    s_cbranch_vccnz L_pollA
L_haveA:
    v_max3_f32 v7, v18, v24, v26
    v_max_f32 v7, v7, v28
    v_sub_f32 v36, v18, v7
    v_sub_f32 v37, v24, v7
    v_sub_f32 v38, v26, v7
    v_sub_f32 v39, v28, v7
    v_exp_f32 v36, v36
    v_exp_f32 v37, v37
    v_exp_f32 v38, v38
    v_exp_f32 v39, v39
    s_nop 0
    v_mul_f32 v8, v36, v19
    v_fmac_f32 v8, v37, v25
    v_fmac_f32 v8, v38, v27
    v_fmac_f32 v8, v39, v29
    v_rcp_f32 v8, v8
    s_nop 0
    v_mul_f32 v36, v36, v8
    v_mul_f32 v37, v37, v8
    v_mul_f32 v38, v38, v8
    v_mul_f32 v39, v39, v8
    buffer_load_dwordx2 v[30:31], v15, s[32:35], s53 offen offset:0 sc1
    buffer_load_dwordx2 v[32:33], v15, s[32:35], s54 offen offset:512 sc1
    buffer_load_dwordx2 v[34:35], v15, s[32:35], s55 offen offset:1024 sc1
L_scale:
    v_mul_f32 v16, v36, v16
    v_mul_f32 v17, v36, v17
L_pollB:
    s_waitcnt vmcnt(0)
    v_max3_u32 v14, v30, v31, v32
    v_fma_f32 v80, v37, v30, v16
    v_fma_f32 v81, v37, v31, v17
    v_max3_u32 v14, v14, v33, v34
    v_fmac_f32 v80, v38, v32
    v_fmac_f32 v81, v38, v33
    v_max_u32 v14, v14, v35
    v_fmac_f32 v80, v39, v34
    v_fmac_f32 v81, v39, v35
    v_cmp_eq_u32 vcc, -1, v14
    v_cvt_pk_bf16_f32 v80, v80, v81
    s_cbranch_vccz L_haveB
    s_sub_u32 s59, s59, 1
    s_cbranch_scc1 L_haveB
    s_and_b32 s41, s59, 7
    s_cbranch_scc1 L_reB
    global_load_ushort v14, v12, s[12:13] offset:128 sc1
    s_waitcnt vmcnt(0)
    v_readfirstlane_b32 s41, v14
    s_bitcmp1_b32 s41, 0
    s_cselect_b32 s42, 0x100000, 0
    s_or_b32 s53, s53, s42
    s_bitcmp1_b32 s41, 1
    s_cselect_b32 s42, 0x100000, 0
    s_or_b32 s54, s54, s42
    s_bitcmp1_b32 s41, 2
    s_cselect_b32 s42, 0x100000, 0
    s_or_b32 s55, s55, s42
L_reB:
    buffer_load_dwordx2 v[30:31], v15, s[32:35], s53 offen offset:0 sc1
    buffer_load_dwordx2 v[32:33], v15, s[32:35], s54 offen offset:512 sc1
    buffer_load_dwordx2 v[34:35], v15, s[32:35], s55 offen offset:1024 sc1
    s_branch L_pollB
L_haveB:
    buffer_store_dword v80, v2, s[28:31], s52 offen
    s_endpgm
L_prod:
    s_waitcnt vmcnt(2)
    v_perm_b32 v82, v132, v128, s60
    v_perm_b32 v86, v132, v128, s61
    v_perm_b32 v90, v133, v129, s60
    v_perm_b32 v94, v133, v129, s61
    v_perm_b32 v98, v134, v130, s60
    v_perm_b32 v102, v134, v130, s61
    v_perm_b32 v106, v135, v131, s60
    v_perm_b32 v110, v135, v131, s61
    s_waitcnt vmcnt(0)
    v_perm_b32 v83, v140, v136, s60
    v_perm_b32 v87, v140, v136, s61
    v_perm_b32 v91, v141, v137, s60
    v_mfma_f32_16x16x32_bf16 v[56:59], v[64:67], v[80:83], v[56:59]
    v_perm_b32 v95, v141, v137, s61
    v_mfma_f32_16x16x32_bf16 v[60:63], v[64:67], v[84:87], v[60:63]
    v_perm_b32 v99, v142, v138, s60
    v_mfma_f32_16x16x32_bf16 v[56:59], v[68:71], v[88:91], v[56:59]
    v_perm_b32 v103, v142, v138, s61
    v_mfma_f32_16x16x32_bf16 v[60:63], v[68:71], v[92:95], v[60:63]
    v_perm_b32 v107, v143, v139, s60
    v_mfma_f32_16x16x32_bf16 v[56:59], v[72:75], v[96:99], v[56:59]
    v_perm_b32 v111, v143, v139, s61
    v_mfma_f32_16x16x32_bf16 v[60:63], v[72:75], v[100:103], v[60:63]
    v_mfma_f32_16x16x32_bf16 v[56:59], v[76:79], v[104:107], v[56:59]
    v_mfma_f32_16x16x32_bf16 v[60:63], v[76:79], v[108:111], v[60:63]
    s_nop 7
    ds_write2st64_b32 v4, v56, v60 offset0:0 offset1:1
    ds_write2st64_b32 v4, v57, v61 offset0:2 offset1:3
    ds_write2st64_b32 v4, v58, v62 offset0:4 offset1:5
    ds_write2st64_b32 v4, v59, v63 offset0:6 offset1:7
    s_waitcnt lgkmcnt(0)
    s_barrier
    ds_read2st64_b32 v[80:81], v6 offset0:0 offset1:1
    ds_read2st64_b32 v[82:83], v6 offset0:8 offset1:9
    ds_read2st64_b32 v[84:85], v6 offset0:16 offset1:17
    ds_read2st64_b32 v[86:87], v6 offset0:24 offset1:25
    s_waitcnt lgkmcnt(2)
    v_pk_add_f32 v[80:81], v[80:81], v[82:83]
    s_waitcnt lgkmcnt(0)
    v_pk_add_f32 v[84:85], v[84:85], v[86:87]
    v_pk_add_f32 v[16:17], v[80:81], v[84:85]
    v_min_u32 v16, s43, v16
    v_min_u32 v17, s43, v17
    s_cmp_lg_u32 s41, s40
    s_cbranch_scc1 L_slow
    buffer_store_dwordx2 v[16:17], v15, s[32:35], s47 offen
    s_endpgm
L_slow:
    s_or_b32 s47, s47, 0x100000
    s_or_b32 s48, s48, 0x100000
    buffer_store_dwordx2 v[16:17], v15, s[32:35], s47 offen sc1
    s_mov_b64 exec, 1
    buffer_store_dwordx2 v[18:19], v13, s[32:35], s48 offen offset:1536 sc1
    s_and_b32 s42, s38, 1
    s_lshl_b32 s42, s42, 4
    s_add_u32 s41, s46, s42
    s_lshl_b32 s41, 1, s41
    s_andn2_b32 s42, s36, 3
    v_mov_b32 v12, s42
    v_mov_b32 v14, s41
    s_waitcnt vmcnt(0)
    s_barrier
    s_cmp_lg_u32 s3, 0
    s_cbranch_scc1 L_flagged
    global_atomic_or v12, v14, s[12:13] offset:128 sc1
L_flagged:
    s_mov_b64 exec, -1
L_end:
    s_endpgm
.section .rodata,"a"
.p2align 6
.amdhsa_kernel standalone__gqa_softmax__sampling_kernel
  .amdhsa_next_free_vgpr 512
  .amdhsa_next_free_sgpr 64
  .amdhsa_accum_offset 256
  .amdhsa_group_segment_fixed_size 0
  .amdhsa_kernarg_size 48
  .amdhsa_user_sgpr_count 2
  .amdhsa_user_sgpr_kernarg_segment_ptr 1
  .amdhsa_system_sgpr_workgroup_id_x 1
.end_amdhsa_kernel
```
